```python
import torch

def _softmax(x, axis=-1):
    return torch.softmax(x, dim=axis)
def _gelu(x):
    return torch.nn.functional.gelu(x, approximate="tanh")
def _silu(x):
    return torch.nn.functional.silu(x)
def _sigmoid(x):
    return torch.sigmoid(x)
def _layernorm(x, axis=-1, eps=1e-5):
    m = x.mean(dim=axis, keepdim=True)
    v = x.var(dim=axis, keepdim=True, unbiased=False)
    return (x - m) / torch.sqrt(v + eps)
def _scatter_add(tgt, idx, src, axis=0):
    return tgt.clone().index_add_(axis, idx, src)
def _segment_sum(src, seg, n):
    out = torch.zeros((n,) + src.shape[1:], dtype=src.dtype)
    return out.index_add_(0, seg, src)
def _pad(x, pw):
    flat = tuple(v for pair in reversed(pw) for v in pair)
    return torch.nn.functional.pad(x, flat)

kernel_name = 'parallel_sum__grouped_kv_mqa__dense_activation_relu__prompt'

def setup_inputs():

    _w = (lambda a: (lambda t: t.to(torch.bfloat16) if t.is_floating_point() else t)(torch.as_tensor(a)))
    def _A_setup():
        B, S, D, H = 1, 2048, 640, 32
        Dh = D // H
        return {
            "x": _w((lambda *s: torch.randn(*s, dtype=torch.bfloat16) * 0.05)(B, S, D)),
            "wq": _w((lambda *s: torch.randn(*s, dtype=torch.bfloat16) * 0.1)(D, H * Dh)),
            "wk": _w((lambda *s: torch.randn(*s, dtype=torch.bfloat16) * 0.1)(D, Dh)),
            "wv": _w((lambda *s: torch.randn(*s, dtype=torch.bfloat16) * 0.05)(D, Dh)),
            "wo": _w((lambda *s: torch.randn(*s, dtype=torch.bfloat16) * 0.05)(H * Dh, D)),
        }
    _A_in = _A_setup()

    def _B_setup():
        B, S, D, Dff = 1, 2048, 640, 1728
        return {
            "x": _w((lambda *s: torch.randn(*s, dtype=torch.bfloat16) * 0.05)(B, S, D)),
            "w1": _w((lambda *s: torch.randn(*s, dtype=torch.bfloat16) * 0.05)(D, Dff)),
            "w2": _w((lambda *s: torch.randn(*s, dtype=torch.bfloat16) * 0.05)(Dff, D)),
        }
    _B_in = _B_setup()

    return {
        "A_x": _A_in["x"],
        "A_wq": _A_in["wq"],
        "A_wk": _A_in["wk"],
        "A_wv": _A_in["wv"],
        "A_wo": _A_in["wo"],
        "B_x": _B_in["x"],
        "B_w1": _B_in["w1"],
        "B_w2": _B_in["w2"],
    }

def reference(A_x, A_wq, A_wk, A_wv, A_wo, B_x, B_w1, B_w2):
    def _A_ref(x, wq, wk, wv, wo):
        B, S, D = x.shape
        H = 32
        Dh = D // H
        q = (lambda x, *d: x.permute(*d))((x @ wq).reshape(B, S, H, Dh), 0, 2, 1, 3)
        k = x @ wk
        v = x @ wv
        scores = torch.einsum("bhqd,bkd->bhqk", q, k) * (Dh ** -0.5)
        p = _softmax(scores, axis=-1)
        o = torch.einsum("bhqk,bkd->bhqd", p, v)
        return (lambda x, *d: x.permute(*d))(o, 0, 2, 1, 3).reshape(B, S, H * Dh) @ wo

    def _B_ref(x, w1, w2):
        h = torch.einsum("bsd,df->bsf", x, w1)
        zero = torch.zeros_like(h)
        h = torch.maximum(h, zero)
        return torch.einsum("bsf,fd->bsd", h, w2)

    x = A_x
    xn = _layernorm(x, axis=-1)
    return x + _A_ref(xn, A_wq, A_wk, A_wv, A_wo) + _B_ref(xn, B_w1, B_w2)
```

```asm
; @launch grid=(256,1,1) block=(768,1,1) lds=163840
.amdgcn_target "amdgcn-amd-amdhsa--gfx950"
.text
.p2align 8
.globl parallel_sum__grouped_kv_mqa__dense_activation_relu__prompt_kernel
.type parallel_sum__grouped_kv_mqa__dense_activation_relu__prompt_kernel,@function
parallel_sum__grouped_kv_mqa__dense_activation_relu__prompt_kernel:
    s_cmp_ge_u32 s2, 256
    s_cbranch_scc1 F_end
    s_load_dwordx8 s[20:27], s[0:1], 0
    s_load_dwordx2 s[28:29], s[0:1], 48
    s_load_dwordx2 s[30:31], s[0:1], 80
    s_load_dwordx2 s[56:57], s[0:1], 56
    s_load_dwordx2 s[58:59], s[0:1], 32
    s_load_dwordx4 s[60:63], s[0:1], 64
    v_lshrrev_b32 v1, 6, v0
    v_and_b32 v0, 63, v0
    v_readfirstlane_b32 s32, v1
    s_and_b32 s33, s2, 3
    s_lshl_b32 s33, s33, 2
    s_bfe_u32 s45, s2, 0x20003
    s_add_u32 s33, s33, s45
    s_lshr_b32 s34, s2, 5
    s_add_u32 s46, s34, s45
    s_and_b32 s46, s46, 1
    s_bfe_u32 s45, s2, 0x10002
    s_lshl_b32 s45, s45, 3
    s_add_u32 s34, s34, s45
    s_lshl_b32 s34, s34, 2
    s_mov_b32 s54, 0x3210fba9
    s_mov_b32 s55, 0x87654edc
    s_lshr_b64 s[54:55], s[54:55], s34
    s_and_b32 s34, s54, 15
    s_lshl_b32 s3, s33, 4
    s_add_u32 s3, s3, s34
    s_sub_u32 s45, s34, 9
    s_cmp_le_u32 s45, 5
    s_cselect_b32 s45, 2, 0
    s_add_u32 s46, s46, s45
    s_mov_b32 s54, 0x76543210
    s_movk_i32 s55, 0x98
    s_cmp_eq_u32 s46, 1
    s_cselect_b32 s54, 0x21098765, s54
    s_cselect_b32 s55, 0x43, s55
    s_cmp_eq_u32 s46, 2
    s_cselect_b32 s54, 0x83726150, s54
    s_cselect_b32 s55, 0x94, s55
    s_cmp_eq_u32 s46, 3
    s_cselect_b32 s54, 0x38271605, s54
    s_cselect_b32 s55, 0x49, s55
    s_mov_b32 s49, 40960
    s_mul_i32 s51, s33, 163840
    s_cmp_ge_u32 s32, 4
    s_cbranch_scc1 A_other
    s_cmp_lt_u32 s34, 9
    s_cbranch_scc1 A_lh
    s_cmp_ge_u32 s34, 14
    s_cbranch_scc1 A_lk
    s_sub_u32 s34, s34, 9
    s_movk_i32 s52, 1280
    s_mov_b32 s39, 81920
    s_mul_i32 s53, s34, 256
    v_lshrrev_b32 v1, 3, v0
    s_lshl_b32 s45, s32, 5
    v_add_u32 v1, s45, v1
    v_mul_u32_u24 v1, 1280, v1
    v_and_b32 v2, 7, v0
    v_lshrrev_b32 v3, 4, v0
    v_xor_b32 v2, v2, v3
    v_lshl_add_u32 v4, v2, 4, v1
    v_xor_b32 v2, 4, v2
    v_lshl_add_u32 v5, v2, 4, v1
    v_add_u32 v5, 9216, v5
    v_add_u32 v6, 18432, v4
    v_add_u32 v7, 18432, v5
    s_lshl_b32 s40, s32, 12
    s_mov_b32 s48, 0
    s_mul_i32 s41, s32, 4096
    s_add_u32 s41, s41, 16384
    s_lshl_b32 s45, s32, 4
    s_mul_i32 s45, s45, s52
    s_add_u32 s45, s45, s53
    v_add_u32 v1, 0, v0
    v_lshrrev_b32 v2, 4, v1
    v_and_b32 v3, 15, v1
    v_and_b32 v1, 3, v2
    v_lshlrev_b32 v1, 2, v1
    v_xor_b32 v3, v3, v1
    v_mul_lo_u32 v2, v2, s52
    v_lshl_add_u32 v2, v3, 4, v2
    v_add_u32 v8, s45, v2
    v_add_u32 v1, 64, v0
    v_lshrrev_b32 v2, 4, v1
    v_and_b32 v3, 15, v1
    v_and_b32 v1, 3, v2
    v_lshlrev_b32 v1, 2, v1
    v_xor_b32 v3, v3, v1
    v_mul_lo_u32 v2, v2, s52
    v_lshl_add_u32 v2, v3, 4, v2
    v_add_u32 v9, s45, v2
    v_add_u32 v10, 8192, v8
    v_add_u32 v11, 7168, v9
    v_subrev_u32 v9, 1024, v9
    s_waitcnt lgkmcnt(0)
    s_mov_b32 s4, s20
    s_and_b32 s5, s21, 0xffff
    s_mov_b32 s6, 2621440
    s_mov_b32 s7, 0x20000
    s_mov_b32 s8, s22
    s_and_b32 s9, s23, 0xffff
    s_mov_b32 s10, 819200
    s_mov_b32 s11, 0x20000
    s_and_b32 s50, s54, 15
    s_lshr_b64 s[54:55], s[54:55], 4
    s_lshl_b32 s37, s50, 7
    s_add_u32 s37, s37, s51
    s_add_u32 m0, s48, s40
    s_mul_i32 s38, s50, s39
    buffer_load_dwordx4 v4, s[4:7], s37 offen offset:0 lds
    buffer_load_dwordx4 v5, s[4:7], s37 offen offset:1024 lds
    buffer_load_dwordx4 v6, s[4:7], s37 offen offset:2048 lds
    buffer_load_dwordx4 v7, s[4:7], s37 offen offset:3072 lds
    s_add_u32 m0, s48, s41
    s_nop 0
    buffer_load_dwordx4 v8, s[8:11], s38 offen offset:0 lds
    buffer_load_dwordx4 v9, s[8:11], s38 offen offset:1024 lds
    buffer_load_dwordx4 v10, s[8:11], s38 offen offset:2048 lds
    buffer_load_dwordx4 v11, s[8:11], s38 offen offset:3072 lds
    s_mov_b32 s12, s30
    s_and_b32 s13, s31, 0xffff
    s_mov_b32 s14, 31457280
    s_mov_b32 s15, 0x20000
    s_mov_b32 s48, 40960
    s_and_b32 s50, s54, 15
    s_lshr_b64 s[54:55], s[54:55], 4
    s_lshl_b32 s37, s50, 7
    s_add_u32 s37, s37, s51
    s_add_u32 m0, s48, s40
    s_mul_i32 s38, s50, s39
    buffer_load_dwordx4 v4, s[4:7], s37 offen offset:0 lds
    buffer_load_dwordx4 v5, s[4:7], s37 offen offset:1024 lds
    buffer_load_dwordx4 v6, s[4:7], s37 offen offset:2048 lds
    buffer_load_dwordx4 v7, s[4:7], s37 offen offset:3072 lds
    s_add_u32 m0, s48, s41
    s_nop 0
    buffer_load_dwordx4 v8, s[8:11], s38 offen offset:0 lds
    buffer_load_dwordx4 v9, s[8:11], s38 offen offset:1024 lds
    buffer_load_dwordx4 v10, s[8:11], s38 offen offset:2048 lds
    buffer_load_dwordx4 v11, s[8:11], s38 offen offset:3072 lds
    s_mov_b32 s35, 0
    s_mov_b32 s48, 81920
AL_loop_q:
    s_waitcnt vmcnt(8)
    s_barrier
    s_and_b32 s50, s54, 15
    s_lshr_b64 s[54:55], s[54:55], 4
    s_lshl_b32 s37, s50, 7
    s_add_u32 s37, s37, s51
    s_add_u32 m0, s48, s40
    s_mul_i32 s38, s50, s39
    buffer_load_dwordx4 v4, s[4:7], s37 offen offset:0 lds
    buffer_load_dwordx4 v5, s[4:7], s37 offen offset:1024 lds
    buffer_load_dwordx4 v6, s[4:7], s37 offen offset:2048 lds
    buffer_load_dwordx4 v7, s[4:7], s37 offen offset:3072 lds
    s_add_u32 m0, s48, s41
    s_nop 0
    buffer_load_dwordx4 v8, s[8:11], s38 offen offset:0 lds
    buffer_load_dwordx4 v9, s[8:11], s38 offen offset:1024 lds
    buffer_load_dwordx4 v10, s[8:11], s38 offen offset:2048 lds
    buffer_load_dwordx4 v11, s[8:11], s38 offen offset:3072 lds
    s_add_u32 s48, s48, s49
    s_cmp_eq_u32 s48, 122880
    s_cselect_b32 s48, 0, s48
    s_add_u32 s35, s35, 1
    s_cmp_lt_u32 s35, 8
    s_cbranch_scc1 AL_loop_q
    s_waitcnt vmcnt(8)
    s_barrier
    s_waitcnt vmcnt(0)
    s_and_b32 s64, s2, 1
    s_lshl_b32 s64, s64, 3
    s_lshr_b32 s35, s2, 5
    s_add_u32 s64, s64, s35
    s_lshl_b32 s64, s64, 2
    s_bfe_u32 s35, s2, 0x20001
    s_add_u32 s64, s64, s35
    s_lshl_b32 s64, s64, 2
    s_bfe_u32 s35, s2, 0x20003
    s_add_u32 s64, s64, s35
    s_and_b32 s35, s64, 3
    s_lshl_b32 s35, s35, 3
    s_add_u32 s35, s35, s32
    s_mul_i32 s35, s35, 5
    v_lshrrev_b32 v2, 5, v0
    v_and_b32 v3, 31, v0
    v_lshlrev_b32 v3, 4, v3
    v_add_u32 v1, s35, v2
    v_lshrrev_b32 v130, 2, v1
    v_lshl_add_u32 v126, v130, 10, v3
    v_and_b32 v130, 1, v1
    v_lshl_add_u32 v126, v130, 9, v126
    v_bfe_u32 v130, v1, 1, 1
    v_lshl_add_u32 v126, v130, 3, v126
    v_add_u32 v1, s35, v2
    v_add_u32 v1, 2, v1
    v_lshrrev_b32 v130, 2, v1
    v_lshl_add_u32 v127, v130, 10, v3
    v_and_b32 v130, 1, v1
    v_lshl_add_u32 v127, v130, 9, v127
    v_bfe_u32 v130, v1, 1, 1
    v_lshl_add_u32 v127, v130, 3, v127
    v_mov_b32 v1, s35
    v_add_u32 v1, 4, v1
    v_lshrrev_b32 v130, 2, v1
    v_lshl_add_u32 v128, v130, 10, v3
    v_and_b32 v130, 1, v1
    v_lshl_add_u32 v128, v130, 9, v128
    v_bfe_u32 v130, v1, 1, 1
    v_lshl_add_u32 v128, v130, 3, v128
    v_lshlrev_b32 v136, 4, v0
    v_add_u32 v124, 135168, v136
    v_lshlrev_b32 v137, 2, v0
    v_add_u32 v137, 163072, v137
    v_cmp_eq_u32 vcc, 0, v0
    s_nop 1
    v_cndmask_b32 v138, 0, 1, vcc
    v_and_b32 v1, 31, v0
    v_min_u32 v1, 23, v1
    v_mul_u32_u24 v125, 384, v2
    v_lshl_add_u32 v125, v1, 4, v125
    v_add_u32 v125, 138240, v125
    s_lshr_b32 s33, s64, 2
    s_and_b32 s34, s64, 3
    s_lshr_b32 s35, s33, 2
    v_mov_b32 v1, s35
    s_add_u32 s36, s34, 9
    v_add_u32 v2, s36, v0
    v_lshl_add_u32 v4, v1, 4, v2
    v_lshlrev_b32 v4, 7, v4
    v_add_u32 v4, 19922944, v4
    s_mov_b64 exec, 3
    v_mov_b32 v6, 0
    s_mov_b64 exec, -1
    s_barrier
    s_branch F_fetch
A_lh:
    s_movk_i32 s52, 3456
    s_mov_b32 s39, 221184
    s_mul_i32 s53, s34, 384
    v_lshrrev_b32 v1, 3, v0
    s_lshl_b32 s45, s32, 5
    v_add_u32 v1, s45, v1
    v_mul_u32_u24 v1, 1280, v1
    v_and_b32 v2, 7, v0
    v_lshrrev_b32 v3, 4, v0
    v_xor_b32 v2, v2, v3
    v_lshl_add_u32 v4, v2, 4, v1
    v_xor_b32 v2, 4, v2
    v_lshl_add_u32 v5, v2, 4, v1
    v_add_u32 v5, 9216, v5
    v_add_u32 v6, 18432, v4
    v_add_u32 v7, 18432, v5
    s_lshl_b32 s40, s32, 12
    s_mov_b32 s48, 0
    s_mul_i32 s41, s32, 6144
    s_add_u32 s41, s41, 16384
    s_lshl_b32 s45, s32, 4
    s_mul_i32 s45, s45, s52
    s_add_u32 s45, s45, s53
    v_add_u32 v1, 0, v0
    v_mul_u32_u24 v2, 0xaaab, v1
    v_lshrrev_b32 v2, 20, v2
    v_mul_u32_u24 v3, 24, v2
    v_sub_u32 v3, v1, v3
    v_bfe_u32 v1, v2, 1, 1
    v_lshlrev_b32 v1, 2, v1
    v_xor_b32 v3, v3, v1
    v_mul_lo_u32 v2, v2, s52
    v_lshl_add_u32 v2, v3, 4, v2
    v_add_u32 v8, s45, v2
    v_add_u32 v1, 64, v0
    v_mul_u32_u24 v2, 0xaaab, v1
    v_lshrrev_b32 v2, 20, v2
    v_mul_u32_u24 v3, 24, v2
    v_sub_u32 v3, v1, v3
    v_bfe_u32 v1, v2, 1, 1
    v_lshlrev_b32 v1, 2, v1
    v_xor_b32 v3, v3, v1
    v_mul_lo_u32 v2, v2, s52
    v_lshl_add_u32 v2, v3, 4, v2
    v_add_u32 v9, s45, v2
    v_add_u32 v1, 128, v0
    v_mul_u32_u24 v2, 0xaaab, v1
    v_lshrrev_b32 v2, 20, v2
    v_mul_u32_u24 v3, 24, v2
    v_sub_u32 v3, v1, v3
    v_bfe_u32 v1, v2, 1, 1
    v_lshlrev_b32 v1, 2, v1
    v_xor_b32 v3, v3, v1
    v_mul_lo_u32 v2, v2, s52
    v_lshl_add_u32 v2, v3, 4, v2
    v_add_u32 v10, s45, v2
    v_add_u32 v11, 24576, v8
    v_add_u32 v12, 27648, v9
    v_add_u32 v13, 26624, v10
    v_subrev_u32 v9, 1024, v9
    v_subrev_u32 v10, 2048, v10
    s_waitcnt lgkmcnt(0)
    s_mov_b32 s4, s20
    s_and_b32 s5, s21, 0xffff
    s_mov_b32 s6, 2621440
    s_mov_b32 s7, 0x20000
    s_mov_b32 s8, s28
    s_and_b32 s9, s29, 0xffff
    s_mov_b32 s10, 2211840
    s_mov_b32 s11, 0x20000
    s_and_b32 s50, s54, 15
    s_lshr_b64 s[54:55], s[54:55], 4
    s_lshl_b32 s37, s50, 7
    s_add_u32 s37, s37, s51
    s_add_u32 m0, s48, s40
    s_mul_i32 s38, s50, s39
    buffer_load_dwordx4 v4, s[4:7], s37 offen offset:0 lds
    buffer_load_dwordx4 v5, s[4:7], s37 offen offset:1024 lds
    buffer_load_dwordx4 v6, s[4:7], s37 offen offset:2048 lds
    buffer_load_dwordx4 v7, s[4:7], s37 offen offset:3072 lds
    s_add_u32 m0, s48, s41
    s_nop 0
    buffer_load_dwordx4 v8, s[8:11], s38 offen offset:0 lds
    buffer_load_dwordx4 v9, s[8:11], s38 offen offset:1024 lds
    buffer_load_dwordx4 v10, s[8:11], s38 offen offset:2048 lds
    buffer_load_dwordx4 v11, s[8:11], s38 offen offset:3072 lds
    s_add_u32 m0, m0, 4096
    s_nop 0
    buffer_load_dwordx4 v12, s[8:11], s38 offen offset:0 lds
    buffer_load_dwordx4 v13, s[8:11], s38 offen offset:1024 lds
    s_mov_b32 s12, s30
    s_and_b32 s13, s31, 0xffff
    s_mov_b32 s14, 31457280
    s_mov_b32 s15, 0x20000
    s_mov_b32 s48, 40960
    s_and_b32 s50, s54, 15
    s_lshr_b64 s[54:55], s[54:55], 4
    s_lshl_b32 s37, s50, 7
    s_add_u32 s37, s37, s51
    s_add_u32 m0, s48, s40
    s_mul_i32 s38, s50, s39
    buffer_load_dwordx4 v4, s[4:7], s37 offen offset:0 lds
    buffer_load_dwordx4 v5, s[4:7], s37 offen offset:1024 lds
    buffer_load_dwordx4 v6, s[4:7], s37 offen offset:2048 lds
    buffer_load_dwordx4 v7, s[4:7], s37 offen offset:3072 lds
    s_add_u32 m0, s48, s41
    s_nop 0
    buffer_load_dwordx4 v8, s[8:11], s38 offen offset:0 lds
    buffer_load_dwordx4 v9, s[8:11], s38 offen offset:1024 lds
    buffer_load_dwordx4 v10, s[8:11], s38 offen offset:2048 lds
    buffer_load_dwordx4 v11, s[8:11], s38 offen offset:3072 lds
    s_add_u32 m0, m0, 4096
    s_nop 0
    buffer_load_dwordx4 v12, s[8:11], s38 offen offset:0 lds
    buffer_load_dwordx4 v13, s[8:11], s38 offen offset:1024 lds
    s_mov_b32 s35, 0
    s_mov_b32 s48, 81920
AL_loop_h:
    s_waitcnt vmcnt(10)
    s_barrier
    s_and_b32 s50, s54, 15
    s_lshr_b64 s[54:55], s[54:55], 4
    s_lshl_b32 s37, s50, 7
    s_add_u32 s37, s37, s51
    s_add_u32 m0, s48, s40
    s_mul_i32 s38, s50, s39
    buffer_load_dwordx4 v4, s[4:7], s37 offen offset:0 lds
    buffer_load_dwordx4 v5, s[4:7], s37 offen offset:1024 lds
    buffer_load_dwordx4 v6, s[4:7], s37 offen offset:2048 lds
    buffer_load_dwordx4 v7, s[4:7], s37 offen offset:3072 lds
    s_add_u32 m0, s48, s41
    s_nop 0
    buffer_load_dwordx4 v8, s[8:11], s38 offen offset:0 lds
    buffer_load_dwordx4 v9, s[8:11], s38 offen offset:1024 lds
    buffer_load_dwordx4 v10, s[8:11], s38 offen offset:2048 lds
    buffer_load_dwordx4 v11, s[8:11], s38 offen offset:3072 lds
    s_add_u32 m0, m0, 4096
    s_nop 0
    buffer_load_dwordx4 v12, s[8:11], s38 offen offset:0 lds
    buffer_load_dwordx4 v13, s[8:11], s38 offen offset:1024 lds
    s_add_u32 s48, s48, s49
    s_cmp_eq_u32 s48, 122880
    s_cselect_b32 s48, 0, s48
    s_add_u32 s35, s35, 1
    s_cmp_lt_u32 s35, 8
    s_cbranch_scc1 AL_loop_h
    s_waitcnt vmcnt(10)
    s_barrier
    s_waitcnt vmcnt(0)
    s_and_b32 s64, s2, 1
    s_lshl_b32 s64, s64, 3
    s_lshr_b32 s35, s2, 5
    s_add_u32 s64, s64, s35
    s_lshl_b32 s64, s64, 2
    s_bfe_u32 s35, s2, 0x20001
    s_add_u32 s64, s64, s35
    s_lshl_b32 s64, s64, 2
    s_bfe_u32 s35, s2, 0x20003
    s_add_u32 s64, s64, s35
    s_and_b32 s35, s64, 3
    s_lshl_b32 s35, s35, 3
    s_add_u32 s35, s35, s32
    s_mul_i32 s35, s35, 5
    v_lshrrev_b32 v2, 5, v0
    v_and_b32 v3, 31, v0
    v_lshlrev_b32 v3, 4, v3
    v_add_u32 v1, s35, v2
    v_lshrrev_b32 v130, 2, v1
    v_lshl_add_u32 v126, v130, 10, v3
    v_and_b32 v130, 1, v1
    v_lshl_add_u32 v126, v130, 9, v126
    v_bfe_u32 v130, v1, 1, 1
    v_lshl_add_u32 v126, v130, 3, v126
    v_add_u32 v1, s35, v2
    v_add_u32 v1, 2, v1
    v_lshrrev_b32 v130, 2, v1
    v_lshl_add_u32 v127, v130, 10, v3
    v_and_b32 v130, 1, v1
    v_lshl_add_u32 v127, v130, 9, v127
    v_bfe_u32 v130, v1, 1, 1
    v_lshl_add_u32 v127, v130, 3, v127
    v_mov_b32 v1, s35
    v_add_u32 v1, 4, v1
    v_lshrrev_b32 v130, 2, v1
    v_lshl_add_u32 v128, v130, 10, v3
    v_and_b32 v130, 1, v1
    v_lshl_add_u32 v128, v130, 9, v128
    v_bfe_u32 v130, v1, 1, 1
    v_lshl_add_u32 v128, v130, 3, v128
    v_lshlrev_b32 v136, 4, v0
    v_add_u32 v124, 135168, v136
    v_lshlrev_b32 v137, 2, v0
    v_add_u32 v137, 163072, v137
    v_cmp_eq_u32 vcc, 0, v0
    s_nop 1
    v_cndmask_b32 v138, 0, 1, vcc
    v_and_b32 v1, 31, v0
    v_min_u32 v1, 23, v1
    v_mul_u32_u24 v125, 384, v2
    v_lshl_add_u32 v125, v1, 4, v125
    v_add_u32 v125, 138240, v125
    s_lshr_b32 s33, s64, 2
    s_and_b32 s34, s64, 3
    s_lshr_b32 s35, s33, 2
    v_mov_b32 v1, s35
    s_add_u32 s36, s34, 9
    v_add_u32 v2, s36, v0
    v_lshl_add_u32 v4, v1, 4, v2
    v_lshlrev_b32 v4, 7, v4
    v_add_u32 v4, 19922944, v4
    s_mov_b64 exec, 3
    v_mov_b32 v6, 0
    s_mov_b64 exec, -1
    s_barrier
    s_branch F_fetch
A_lk:
    s_cmp_eq_u32 s34, 15
    s_cbranch_scc1 A_spare
    s_movk_i32 s39, 2560
    v_lshrrev_b32 v1, 3, v0
    s_lshl_b32 s45, s32, 5
    v_add_u32 v1, s45, v1
    v_mul_u32_u24 v1, 1280, v1
    v_and_b32 v2, 7, v0
    v_lshrrev_b32 v3, 4, v0
    v_xor_b32 v2, v2, v3
    v_lshl_add_u32 v4, v2, 4, v1
    v_xor_b32 v2, 4, v2
    v_lshl_add_u32 v5, v2, 4, v1
    v_add_u32 v5, 9216, v5
    v_add_u32 v6, 18432, v4
    v_add_u32 v7, 18432, v5
    s_lshl_b32 s40, s32, 12
    s_mov_b32 s48, 0
    s_lshl_b32 s41, s32, 10
    s_add_u32 s41, s41, 16384
    v_lshrrev_b32 v1, 2, v0
    s_lshl_b32 s45, s32, 4
    v_add_u32 v1, s45, v1
    v_mul_u32_u24 v1, 40, v1
    v_and_b32 v2, 3, v0
    v_lshl_add_u32 v8, v2, 4, v1
    s_waitcnt lgkmcnt(0)
    s_mov_b32 s4, s20
    s_and_b32 s5, s21, 0xffff
    s_mov_b32 s6, 2621440
    s_mov_b32 s7, 0x20000
    s_mov_b32 s8, s24
    s_and_b32 s9, s25, 0xffff
    s_mov_b32 s10, 25600
    s_mov_b32 s11, 0x20000
    s_mov_b32 s16, s26
    s_and_b32 s17, s27, 0xffff
    s_mov_b32 s18, 25600
    s_mov_b32 s19, 0x20000
    s_and_b32 s50, s54, 15
    s_lshr_b64 s[54:55], s[54:55], 4
    s_lshl_b32 s37, s50, 7
    s_add_u32 s37, s37, s51
    s_add_u32 m0, s48, s40
    s_mul_i32 s38, s50, s39
    buffer_load_dwordx4 v4, s[4:7], s37 offen offset:0 lds
    buffer_load_dwordx4 v5, s[4:7], s37 offen offset:1024 lds
    buffer_load_dwordx4 v6, s[4:7], s37 offen offset:2048 lds
    buffer_load_dwordx4 v7, s[4:7], s37 offen offset:3072 lds
    s_add_u32 m0, s48, s41
    s_nop 0
    buffer_load_dwordx4 v8, s[8:11], s38 offen lds
    s_add_u32 m0, m0, 4096
    s_nop 0
    buffer_load_dwordx4 v8, s[16:19], s38 offen lds
    s_mov_b32 s12, s30
    s_and_b32 s13, s31, 0xffff
    s_mov_b32 s14, 31457280
    s_mov_b32 s15, 0x20000
    s_mov_b32 s48, 40960
    s_and_b32 s50, s54, 15
    s_lshr_b64 s[54:55], s[54:55], 4
    s_lshl_b32 s37, s50, 7
    s_add_u32 s37, s37, s51
    s_add_u32 m0, s48, s40
    s_mul_i32 s38, s50, s39
    buffer_load_dwordx4 v4, s[4:7], s37 offen offset:0 lds
    buffer_load_dwordx4 v5, s[4:7], s37 offen offset:1024 lds
    buffer_load_dwordx4 v6, s[4:7], s37 offen offset:2048 lds
    buffer_load_dwordx4 v7, s[4:7], s37 offen offset:3072 lds
    s_add_u32 m0, s48, s41
    s_nop 0
    buffer_load_dwordx4 v8, s[8:11], s38 offen lds
    s_add_u32 m0, m0, 4096
    s_nop 0
    buffer_load_dwordx4 v8, s[16:19], s38 offen lds
    s_mov_b32 s35, 0
    s_mov_b32 s48, 81920
AL_loop_kv:
    s_waitcnt vmcnt(6)
    s_barrier
    s_and_b32 s50, s54, 15
    s_lshr_b64 s[54:55], s[54:55], 4
    s_lshl_b32 s37, s50, 7
    s_add_u32 s37, s37, s51
    s_add_u32 m0, s48, s40
    s_mul_i32 s38, s50, s39
    buffer_load_dwordx4 v4, s[4:7], s37 offen offset:0 lds
    buffer_load_dwordx4 v5, s[4:7], s37 offen offset:1024 lds
    buffer_load_dwordx4 v6, s[4:7], s37 offen offset:2048 lds
    buffer_load_dwordx4 v7, s[4:7], s37 offen offset:3072 lds
    s_add_u32 m0, s48, s41
    s_nop 0
    buffer_load_dwordx4 v8, s[8:11], s38 offen lds
    s_add_u32 m0, m0, 4096
    s_nop 0
    buffer_load_dwordx4 v8, s[16:19], s38 offen lds
    s_add_u32 s48, s48, s49
    s_cmp_eq_u32 s48, 122880
    s_cselect_b32 s48, 0, s48
    s_add_u32 s35, s35, 1
    s_cmp_lt_u32 s35, 8
    s_cbranch_scc1 AL_loop_kv
    s_waitcnt vmcnt(6)
    s_barrier
    s_waitcnt vmcnt(0)
    s_and_b32 s64, s2, 1
    s_lshl_b32 s64, s64, 3
    s_lshr_b32 s35, s2, 5
    s_add_u32 s64, s64, s35
    s_lshl_b32 s64, s64, 2
    s_bfe_u32 s35, s2, 0x20001
    s_add_u32 s64, s64, s35
    s_lshl_b32 s64, s64, 2
    s_bfe_u32 s35, s2, 0x20003
    s_add_u32 s64, s64, s35
    s_and_b32 s35, s64, 3
    s_lshl_b32 s35, s35, 3
    s_add_u32 s35, s35, s32
    s_mul_i32 s35, s35, 5
    v_lshrrev_b32 v2, 5, v0
    v_and_b32 v3, 31, v0
    v_lshlrev_b32 v3, 4, v3
    v_add_u32 v1, s35, v2
    v_lshrrev_b32 v130, 2, v1
    v_lshl_add_u32 v126, v130, 10, v3
    v_and_b32 v130, 1, v1
    v_lshl_add_u32 v126, v130, 9, v126
    v_bfe_u32 v130, v1, 1, 1
    v_lshl_add_u32 v126, v130, 3, v126
    v_add_u32 v1, s35, v2
    v_add_u32 v1, 2, v1
    v_lshrrev_b32 v130, 2, v1
    v_lshl_add_u32 v127, v130, 10, v3
    v_and_b32 v130, 1, v1
    v_lshl_add_u32 v127, v130, 9, v127
    v_bfe_u32 v130, v1, 1, 1
    v_lshl_add_u32 v127, v130, 3, v127
    v_mov_b32 v1, s35
    v_add_u32 v1, 4, v1
    v_lshrrev_b32 v130, 2, v1
    v_lshl_add_u32 v128, v130, 10, v3
    v_and_b32 v130, 1, v1
    v_lshl_add_u32 v128, v130, 9, v128
    v_bfe_u32 v130, v1, 1, 1
    v_lshl_add_u32 v128, v130, 3, v128
    v_lshlrev_b32 v136, 4, v0
    v_add_u32 v124, 135168, v136
    v_lshlrev_b32 v137, 2, v0
    v_add_u32 v137, 163072, v137
    v_cmp_eq_u32 vcc, 0, v0
    s_nop 1
    v_cndmask_b32 v138, 0, 1, vcc
    v_and_b32 v1, 31, v0
    v_min_u32 v1, 23, v1
    v_mul_u32_u24 v125, 384, v2
    v_lshl_add_u32 v125, v1, 4, v125
    v_add_u32 v125, 138240, v125
    s_lshr_b32 s33, s64, 2
    s_and_b32 s34, s64, 3
    s_lshr_b32 s35, s33, 2
    v_mov_b32 v1, s35
    s_add_u32 s36, s34, 9
    v_add_u32 v2, s36, v0
    v_lshl_add_u32 v4, v1, 4, v2
    v_lshlrev_b32 v4, 7, v4
    v_add_u32 v4, 19922944, v4
    s_mov_b64 exec, 3
    v_mov_b32 v6, 0
    s_mov_b64 exec, -1
    s_barrier
    s_branch F_fetch
A_other:
    s_cmp_eq_u32 s34, 15
    s_cbranch_scc1 A_spare
    s_waitcnt lgkmcnt(0)
    s_mov_b32 s4, s20
    s_and_b32 s5, s21, 0xffff
    s_mov_b32 s6, 2621440
    s_mov_b32 s7, 0x20000
    s_mov_b32 s12, s30
    s_and_b32 s13, s31, 0xffff
    s_mov_b32 s14, 31457280
    s_mov_b32 s15, 0x20000
    s_cmp_lt_u32 s32, 8
    s_cbranch_scc1 A_stats
    s_setprio 3
    s_and_b32 s40, s32, 1
    s_bfe_u32 s41, s32, 0x10001
    s_lshl_b32 s47, s33, 1
    s_add_u32 s47, s47, s40
    s_lshl_b32 s47, s47, 1
    s_cmp_eq_u32 s34, 14
    s_cbranch_scc1 A_ckv
    s_cmp_lt_u32 s34, 9
    s_cbranch_scc1 A_ch
    s_sub_u32 s34, s34, 9
    s_mul_i32 s47, s47, 151552
    s_lshl_b32 s45, s34, 1
    s_add_u32 s45, s45, s41
    s_mul_i32 s45, s45, 4096
    s_add_u32 s47, s47, s45
    v_and_b32 v1, 31, v0
    v_lshrrev_b32 v2, 5, v0
    v_bfe_u32 v3, v0, 1, 3
    v_xor_b32 v3, v3, v2
    v_lshlrev_b32 v3, 4, v3
    v_lshlrev_b32 v1, 7, v1
    s_lshl_b32 s45, s40, 13
    s_add_u32 s45, s45, 81920
    v_add_u32 v1, s45, v1
    v_xor_b32 v4, 0, v3
    v_add_u32 v8, v1, v4
    v_xor_b32 v4, 32, v3
    v_add_u32 v9, v1, v4
    v_xor_b32 v4, 64, v3
    v_add_u32 v10, v1, v4
    v_xor_b32 v4, 96, v3
    v_add_u32 v11, v1, v4
    v_lshrrev_b32 v1, 5, v0
    v_bfe_u32 v2, v0, 2, 2
    v_lshl_add_u32 v1, v1, 3, v2
    v_mul_u32_u24 v1, 256, v1
    v_bfe_u32 v3, v0, 4, 1
    v_lshl_add_u32 v1, v3, 5, v1
    v_and_b32 v3, 3, v0
    v_lshl_add_u32 v1, v3, 3, v1
    v_add_u32 v1, 98304, v1
    s_mul_i32 s45, s41, 2
    s_add_u32 s46, s45, 0
    v_xor_b32 v3, s46, v2
    v_lshl_add_u32 v12, v3, 6, v1
    s_add_u32 s46, s45, 1
    v_xor_b32 v3, s46, v2
    v_lshl_add_u32 v13, v3, 6, v1
    v_lshrrev_b32 v1, 2, v0
    v_lshrrev_b32 v2, 4, v0
    v_xor_b32 v1, v1, v2
    v_and_b32 v1, 1, v1
    v_subrev_u32 v1, 1, v1
    v_and_b32 v56, 0x3f803f80, v1
    v_and_b32 v57, 0x3f803f80, v1
    v_and_b32 v58, 0x3f803f80, v1
    v_and_b32 v59, 0x3f803f80, v1
    v_mov_b32 v36, 0
    v_mov_b32 v37, 0
    v_mov_b32 v38, 0
    v_mov_b32 v39, 0
    v_mov_b32 v40, 0
    v_mov_b32 v41, 0
    v_mov_b32 v42, 0
    v_mov_b32 v43, 0
    v_mov_b32 v44, 0
    v_mov_b32 v45, 0
    v_mov_b32 v46, 0
    v_mov_b32 v47, 0
    v_mov_b32 v48, 0
    v_mov_b32 v49, 0
    v_mov_b32 v50, 0
    v_mov_b32 v51, 0
    v_mfma_f32_32x32x16_bf16 v[72:87], v[36:39], v[36:39], 0
    v_mfma_f32_32x32x16_bf16 v[88:103], v[36:39], v[36:39], 0
    v_mfma_f32_32x32x16_bf16 v[104:119], v[36:39], v[36:39], 0
    v_mfma_f32_32x32x16_bf16 v[120:135], v[36:39], v[36:39], 0
    v_mfma_f32_16x16x32_bf16 v[60:63], v[36:39], v[36:39], 0
    v_mfma_f32_16x16x32_bf16 v[64:67], v[36:39], v[36:39], 0
    s_mov_b32 s35, 0
    s_mov_b32 s36, 81920
    s_cmp_eq_u32 s36, 81920
    s_cselect_b32 s42, 4294885376, s49
    s_add_u32 s36, s36, s42
    v_add_u32 v8, s42, v8
    v_add_u32 v12, s42, v12
    v_add_u32 v13, s42, v13
    v_add_u32 v9, s42, v9
    v_add_u32 v10, s42, v10
    v_add_u32 v11, s42, v11
    s_branch AC_ent_q0
.p2align 6
AC_loop_q0:
    s_waitcnt lgkmcnt(0)
    v_mfma_f32_16x16x32_bf16 v[64:67], v[56:59], v[28:31], v[64:67]
    v_mfma_f32_32x32x16_bf16 v[120:135], v[28:31], v[20:23], v[120:135]
AC_ent_q0:
    s_barrier
    v_mfma_f32_32x32x16_bf16 v[72:87], v[44:47], v[36:39], v[72:87]
    ds_read_b128 v[16:19], v8
    ds_read_b64_tr_b16 v[24:25], v12 offset:0
    v_mfma_f32_32x32x16_bf16 v[104:119], v[44:47], v[40:43], v[104:119]
    ds_read_b64_tr_b16 v[26:27], v12 offset:1024
    ds_read_b128 v[20:23], v8 offset:4096
    v_mfma_f32_16x16x32_bf16 v[60:63], v[56:59], v[44:47], v[60:63]
    v_mfma_f32_32x32x16_bf16 v[88:103], v[48:51], v[36:39], v[88:103]
    ds_read_b64_tr_b16 v[28:29], v13 offset:0
    ds_read_b64_tr_b16 v[30:31], v13 offset:1024
    v_mfma_f32_32x32x16_bf16 v[120:135], v[48:51], v[40:43], v[120:135]
    v_mfma_f32_16x16x32_bf16 v[64:67], v[56:59], v[48:51], v[64:67]
    s_waitcnt lgkmcnt(3)
    v_mfma_f32_32x32x16_bf16 v[72:87], v[24:27], v[16:19], v[72:87]
    ds_read_b128 v[36:39], v9
    ds_read_b64_tr_b16 v[44:45], v12 offset:4096
    s_waitcnt lgkmcnt(4)
    v_mfma_f32_32x32x16_bf16 v[104:119], v[24:27], v[20:23], v[104:119]
    ds_read_b64_tr_b16 v[46:47], v12 offset:5120
    ds_read_b128 v[40:43], v9 offset:4096
    v_mfma_f32_16x16x32_bf16 v[60:63], v[56:59], v[24:27], v[60:63]
    s_waitcnt lgkmcnt(4)
    v_mfma_f32_32x32x16_bf16 v[88:103], v[28:31], v[16:19], v[88:103]
    ds_read_b64_tr_b16 v[48:49], v13 offset:4096
    ds_read_b64_tr_b16 v[50:51], v13 offset:5120
    v_mfma_f32_32x32x16_bf16 v[120:135], v[28:31], v[20:23], v[120:135]
    v_mfma_f32_16x16x32_bf16 v[64:67], v[56:59], v[28:31], v[64:67]
    s_waitcnt lgkmcnt(3)
    v_mfma_f32_32x32x16_bf16 v[72:87], v[44:47], v[36:39], v[72:87]
    ds_read_b128 v[16:19], v10
    ds_read_b64_tr_b16 v[24:25], v12 offset:8192
    s_waitcnt lgkmcnt(4)
    v_mfma_f32_32x32x16_bf16 v[104:119], v[44:47], v[40:43], v[104:119]
    ds_read_b64_tr_b16 v[26:27], v12 offset:9216
    ds_read_b128 v[20:23], v10 offset:4096
    v_mfma_f32_16x16x32_bf16 v[60:63], v[56:59], v[44:47], v[60:63]
    s_waitcnt lgkmcnt(4)
    v_mfma_f32_32x32x16_bf16 v[88:103], v[48:51], v[36:39], v[88:103]
    ds_read_b64_tr_b16 v[28:29], v13 offset:8192
    ds_read_b64_tr_b16 v[30:31], v13 offset:9216
    v_mfma_f32_32x32x16_bf16 v[120:135], v[48:51], v[40:43], v[120:135]
    v_mfma_f32_16x16x32_bf16 v[64:67], v[56:59], v[48:51], v[64:67]
    s_waitcnt lgkmcnt(3)
    v_mfma_f32_32x32x16_bf16 v[72:87], v[24:27], v[16:19], v[72:87]
    ds_read_b128 v[36:39], v11
    ds_read_b64_tr_b16 v[44:45], v12 offset:12288
    ds_read_b64_tr_b16 v[46:47], v12 offset:13312
    s_waitcnt lgkmcnt(5)
    v_mfma_f32_32x32x16_bf16 v[104:119], v[24:27], v[20:23], v[104:119]
    ds_read_b128 v[40:43], v11 offset:4096
    ds_read_b64_tr_b16 v[48:49], v13 offset:12288
    ds_read_b64_tr_b16 v[50:51], v13 offset:13312
    s_cmp_eq_u32 s36, 81920
    s_cselect_b32 s42, 4294885376, s49
    v_mfma_f32_16x16x32_bf16 v[60:63], v[56:59], v[24:27], v[60:63]
    s_waitcnt lgkmcnt(6)
    v_mfma_f32_32x32x16_bf16 v[88:103], v[28:31], v[16:19], v[88:103]
    s_add_u32 s36, s36, s42
    v_add_u32 v8, s42, v8
    v_add_u32 v12, s42, v12
    v_add_u32 v13, s42, v13
    v_add_u32 v9, s42, v9
    v_add_u32 v10, s42, v10
    v_add_u32 v11, s42, v11
    s_add_u32 s35, s35, 1
    s_cmp_lt_u32 s35, 10
    s_cbranch_scc1 AC_loop_q0
    s_waitcnt lgkmcnt(0)
    v_mfma_f32_16x16x32_bf16 v[64:67], v[56:59], v[28:31], v[64:67]
    v_mfma_f32_32x32x16_bf16 v[120:135], v[28:31], v[20:23], v[120:135]
    v_mfma_f32_16x16x32_bf16 v[60:63], v[56:59], v[44:47], v[60:63]
    v_mfma_f32_16x16x32_bf16 v[64:67], v[56:59], v[48:51], v[64:67]
AC_fin_q:
    v_and_b32 v1, 31, v0
    s_lshl_b32 s45, s40, 8
    s_add_u32 s45, s45, 159744
    v_lshl_add_u32 v2, v1, 2, s45
    v_mfma_f32_32x32x16_bf16 v[72:87], v[44:47], v[36:39], v[72:87]
    v_mov_b32 v16, 0
    v_mov_b32 v17, 0
    v_mov_b32 v18, 0
    v_mov_b32 v19, 0
    v_mov_b32 v20, 0
    v_mfma_f32_32x32x16_bf16 v[104:119], v[44:47], v[40:43], v[104:119]
    v_mov_b32 v21, 0
    v_mov_b32 v22, 0
    v_mov_b32 v23, 0
    v_mov_b32 v24, 0
    v_mov_b32 v25, 0
    v_mfma_f32_32x32x16_bf16 v[88:103], v[48:51], v[36:39], v[88:103]
    v_mov_b32 v26, 0
    v_mov_b32 v27, 0
    v_mov_b32 v28, 0
    v_mov_b32 v29, 0
    v_mov_b32 v30, 0
    v_mfma_f32_32x32x16_bf16 v[120:135], v[48:51], v[40:43], v[120:135]
    v_mov_b32 v31, 0
    s_mov_b32 exec_hi, 0
    ds_read_b32 v16, v2
    ds_read_b32 v20, v2 offset:128
    s_mov_b32 exec_hi, -1
    ds_read_b32 v4, v2 offset:512
    ds_read_b32 v6, v2 offset:640
    v_cvt_pk_bf16_f32 v61, v60, v60
    v_cvt_pk_bf16_f32 v65, v64, v64
    v_lshlrev_b32 v61, 16, v61
    v_lshlrev_b32 v65, 16, v65
    v_sub_f32 v61, v60, v61
    v_sub_f32 v65, v64, v65
    v_cvt_pk_bf16_f32 v24, v60, v61
    v_cvt_pk_bf16_f32 v28, v64, v65
    s_waitcnt lgkmcnt(0)
    v_mfma_f32_32x32x16_bf16 v[72:87], v[24:27], v[16:19], v[72:87]
    v_mfma_f32_32x32x16_bf16 v[88:103], v[28:31], v[16:19], v[88:103]
    v_mfma_f32_32x32x16_bf16 v[104:119], v[24:27], v[20:23], v[104:119]
    v_mfma_f32_32x32x16_bf16 v[120:135], v[28:31], v[20:23], v[120:135]
    v_lshlrev_b32 v1, 4, v0
    s_nop 7
    v_mul_f32 v72, v4, v72
    v_mul_f32 v73, v4, v73
    v_mul_f32 v74, v4, v74
    v_mul_f32 v75, v4, v75
    v_mul_f32 v76, v4, v76
    v_mul_f32 v77, v4, v77
    v_mul_f32 v78, v4, v78
    v_mul_f32 v79, v4, v79
    v_mul_f32 v80, v4, v80
    v_mul_f32 v81, v4, v81
    v_mul_f32 v82, v4, v82
    v_mul_f32 v83, v4, v83
    v_mul_f32 v84, v4, v84
    v_mul_f32 v85, v4, v85
    v_mul_f32 v86, v4, v86
    v_mul_f32 v87, v4, v87
    v_cvt_pk_bf16_f32 v72, v72, v73
    v_cvt_pk_bf16_f32 v73, v74, v75
    v_cvt_pk_bf16_f32 v74, v76, v77
    v_cvt_pk_bf16_f32 v75, v78, v79
    v_cvt_pk_bf16_f32 v76, v80, v81
    v_cvt_pk_bf16_f32 v77, v82, v83
    v_cvt_pk_bf16_f32 v78, v84, v85
    v_cvt_pk_bf16_f32 v79, v86, v87
    buffer_store_dwordx4 v[72:75], v1, s[12:15], s47 offen offset:0 sc1
    buffer_store_dwordx4 v[76:79], v1, s[12:15], s47 offen offset:1024 sc1
    v_mul_f32 v88, v4, v88
    v_mul_f32 v89, v4, v89
    v_mul_f32 v90, v4, v90
    v_mul_f32 v91, v4, v91
    v_mul_f32 v92, v4, v92
    v_mul_f32 v93, v4, v93
    v_mul_f32 v94, v4, v94
    v_mul_f32 v95, v4, v95
    v_mul_f32 v96, v4, v96
    v_mul_f32 v97, v4, v97
    v_mul_f32 v98, v4, v98
    v_mul_f32 v99, v4, v99
    v_mul_f32 v100, v4, v100
    v_mul_f32 v101, v4, v101
    v_mul_f32 v102, v4, v102
    v_mul_f32 v103, v4, v103
    v_cvt_pk_bf16_f32 v88, v88, v89
    v_cvt_pk_bf16_f32 v89, v90, v91
    v_cvt_pk_bf16_f32 v90, v92, v93
    v_cvt_pk_bf16_f32 v91, v94, v95
    v_cvt_pk_bf16_f32 v92, v96, v97
    v_cvt_pk_bf16_f32 v93, v98, v99
    v_cvt_pk_bf16_f32 v94, v100, v101
    v_cvt_pk_bf16_f32 v95, v102, v103
    buffer_store_dwordx4 v[88:91], v1, s[12:15], s47 offen offset:2048 sc1
    buffer_store_dwordx4 v[92:95], v1, s[12:15], s47 offen offset:3072 sc1
    s_add_u32 s47, s47, 151552
    v_pk_mul_f32 v[104:105], v[104:105], v[6:7] op_sel_hi:[1,0]
    v_pk_mul_f32 v[106:107], v[106:107], v[6:7] op_sel_hi:[1,0]
    v_pk_mul_f32 v[108:109], v[108:109], v[6:7] op_sel_hi:[1,0]
    v_pk_mul_f32 v[110:111], v[110:111], v[6:7] op_sel_hi:[1,0]
    v_pk_mul_f32 v[112:113], v[112:113], v[6:7] op_sel_hi:[1,0]
    v_pk_mul_f32 v[114:115], v[114:115], v[6:7] op_sel_hi:[1,0]
    v_pk_mul_f32 v[116:117], v[116:117], v[6:7] op_sel_hi:[1,0]
    v_pk_mul_f32 v[118:119], v[118:119], v[6:7] op_sel_hi:[1,0]
    v_cvt_pk_bf16_f32 v104, v104, v105
    v_cvt_pk_bf16_f32 v105, v106, v107
    v_cvt_pk_bf16_f32 v106, v108, v109
    v_cvt_pk_bf16_f32 v107, v110, v111
    v_cvt_pk_bf16_f32 v108, v112, v113
    v_cvt_pk_bf16_f32 v109, v114, v115
    v_cvt_pk_bf16_f32 v110, v116, v117
    v_cvt_pk_bf16_f32 v111, v118, v119
    buffer_store_dwordx4 v[104:107], v1, s[12:15], s47 offen offset:0 sc1
    buffer_store_dwordx4 v[108:111], v1, s[12:15], s47 offen offset:1024 sc1
    v_pk_mul_f32 v[120:121], v[120:121], v[6:7] op_sel_hi:[1,0]
    v_pk_mul_f32 v[122:123], v[122:123], v[6:7] op_sel_hi:[1,0]
    v_pk_mul_f32 v[124:125], v[124:125], v[6:7] op_sel_hi:[1,0]
    v_pk_mul_f32 v[126:127], v[126:127], v[6:7] op_sel_hi:[1,0]
    v_pk_mul_f32 v[128:129], v[128:129], v[6:7] op_sel_hi:[1,0]
    v_pk_mul_f32 v[130:131], v[130:131], v[6:7] op_sel_hi:[1,0]
    v_pk_mul_f32 v[132:133], v[132:133], v[6:7] op_sel_hi:[1,0]
    v_pk_mul_f32 v[134:135], v[134:135], v[6:7] op_sel_hi:[1,0]
    v_cvt_pk_bf16_f32 v120, v120, v121
    v_cvt_pk_bf16_f32 v121, v122, v123
    v_cvt_pk_bf16_f32 v122, v124, v125
    v_cvt_pk_bf16_f32 v123, v126, v127
    v_cvt_pk_bf16_f32 v124, v128, v129
    v_cvt_pk_bf16_f32 v125, v130, v131
    v_cvt_pk_bf16_f32 v126, v132, v133
    v_cvt_pk_bf16_f32 v127, v134, v135
    buffer_store_dwordx4 v[120:123], v1, s[12:15], s47 offen offset:2048 sc1
    buffer_store_dwordx4 v[124:127], v1, s[12:15], s47 offen offset:3072 sc1
    s_branch F_pub
A_ch:
    s_mul_i32 s47, s47, 151552
    s_lshl_b32 s45, s34, 1
    s_add_u32 s45, s45, s41
    s_mul_i32 s45, s45, 6144
    s_add_u32 s47, s47, s45
    s_add_u32 s47, s47, 40960
    v_and_b32 v1, 31, v0
    v_lshrrev_b32 v2, 5, v0
    v_bfe_u32 v3, v0, 1, 3
    v_xor_b32 v3, v3, v2
    v_lshlrev_b32 v3, 4, v3
    v_lshlrev_b32 v1, 7, v1
    s_lshl_b32 s45, s40, 13
    s_add_u32 s45, s45, 81920
    v_add_u32 v1, s45, v1
    v_xor_b32 v4, 0, v3
    v_add_u32 v8, v1, v4
    v_xor_b32 v4, 32, v3
    v_add_u32 v9, v1, v4
    v_xor_b32 v4, 64, v3
    v_add_u32 v10, v1, v4
    v_xor_b32 v4, 96, v3
    v_add_u32 v11, v1, v4
    v_lshrrev_b32 v1, 5, v0
    v_bfe_u32 v2, v0, 2, 2
    v_lshl_add_u32 v1, v1, 3, v2
    v_mul_u32_u24 v1, 384, v1
    v_bfe_u32 v3, v0, 4, 1
    v_lshl_add_u32 v1, v3, 5, v1
    v_and_b32 v3, 3, v0
    v_lshl_add_u32 v1, v3, 3, v1
    v_add_u32 v1, 98304, v1
    v_lshrrev_b32 v2, 1, v2
    s_mul_i32 s45, s41, 3
    s_add_u32 s46, s45, 0
    v_xor_b32 v3, s46, v2
    v_lshl_add_u32 v12, v3, 6, v1
    s_add_u32 s46, s45, 1
    v_xor_b32 v3, s46, v2
    v_lshl_add_u32 v13, v3, 6, v1
    s_add_u32 s46, s45, 2
    v_xor_b32 v3, s46, v2
    v_lshl_add_u32 v14, v3, 6, v1
    v_lshrrev_b32 v1, 2, v0
    v_lshrrev_b32 v2, 4, v0
    v_xor_b32 v1, v1, v2
    v_and_b32 v1, 1, v1
    v_subrev_u32 v1, 1, v1
    v_and_b32 v56, 0x3f803f80, v1
    v_and_b32 v57, 0x3f803f80, v1
    v_and_b32 v58, 0x3f803f80, v1
    v_and_b32 v59, 0x3f803f80, v1
    v_mov_b32 v36, 0
    v_mov_b32 v37, 0
    v_mov_b32 v38, 0
    v_mov_b32 v39, 0
    v_mov_b32 v40, 0
    v_mov_b32 v41, 0
    v_mov_b32 v42, 0
    v_mov_b32 v43, 0
    v_mov_b32 v44, 0
    v_mov_b32 v45, 0
    v_mov_b32 v46, 0
    v_mov_b32 v47, 0
    v_mov_b32 v48, 0
    v_mov_b32 v49, 0
    v_mov_b32 v50, 0
    v_mov_b32 v51, 0
    v_mov_b32 v52, 0
    v_mov_b32 v53, 0
    v_mov_b32 v54, 0
    v_mov_b32 v55, 0
    v_mfma_f32_32x32x16_bf16 v[72:87], v[36:39], v[36:39], 0
    v_mfma_f32_32x32x16_bf16 v[88:103], v[36:39], v[36:39], 0
    v_mfma_f32_32x32x16_bf16 v[104:119], v[36:39], v[36:39], 0
    v_mfma_f32_32x32x16_bf16 v[120:135], v[36:39], v[36:39], 0
    v_mfma_f32_32x32x16_bf16 v[136:151], v[36:39], v[36:39], 0
    v_mfma_f32_32x32x16_bf16 v[152:167], v[36:39], v[36:39], 0
    v_mfma_f32_16x16x32_bf16 v[60:63], v[36:39], v[36:39], 0
    v_mfma_f32_16x16x32_bf16 v[64:67], v[36:39], v[36:39], 0
    v_mfma_f32_16x16x32_bf16 v[68:71], v[36:39], v[36:39], 0
    s_mov_b32 s35, 0
    s_mov_b32 s36, 81920
    s_cmp_eq_u32 s36, 81920
    s_cselect_b32 s42, 4294885376, s49
    s_add_u32 s36, s36, s42
    v_add_u32 v8, s42, v8
    v_add_u32 v12, s42, v12
    v_add_u32 v13, s42, v13
    v_add_u32 v14, s42, v14
    v_add_u32 v9, s42, v9
    v_add_u32 v10, s42, v10
    v_add_u32 v11, s42, v11
    s_cmp_eq_u32 s40, 1
    s_cbranch_scc1 AC_ent_h1
    s_branch AC_ent_h0
.p2align 6
AC_loop_h0:
    s_waitcnt lgkmcnt(0)
    v_mfma_f32_16x16x32_bf16 v[68:71], v[56:59], v[32:35], v[68:71]
    v_mfma_f32_32x32x16_bf16 v[152:167], v[32:35], v[20:23], v[152:167]
AC_ent_h0:
    s_barrier
    v_mfma_f32_32x32x16_bf16 v[72:87], v[44:47], v[36:39], v[72:87]
    ds_read_b128 v[16:19], v8
    ds_read_b64_tr_b16 v[24:25], v12 offset:0
    v_mfma_f32_32x32x16_bf16 v[120:135], v[44:47], v[40:43], v[120:135]
    ds_read_b64_tr_b16 v[26:27], v12 offset:1536
    ds_read_b128 v[20:23], v8 offset:4096
    v_mfma_f32_32x32x16_bf16 v[88:103], v[48:51], v[36:39], v[88:103]
    ds_read_b64_tr_b16 v[28:29], v13 offset:0
    ds_read_b64_tr_b16 v[30:31], v13 offset:1536
    v_mfma_f32_32x32x16_bf16 v[136:151], v[48:51], v[40:43], v[136:151]
    ds_read_b64_tr_b16 v[32:33], v14 offset:0
    ds_read_b64_tr_b16 v[34:35], v14 offset:1536
    v_mfma_f32_32x32x16_bf16 v[104:119], v[52:55], v[36:39], v[104:119]
    v_mfma_f32_32x32x16_bf16 v[152:167], v[52:55], v[40:43], v[152:167]
    s_waitcnt lgkmcnt(5)
    v_mfma_f32_32x32x16_bf16 v[72:87], v[24:27], v[16:19], v[72:87]
    ds_read_b128 v[36:39], v9
    ds_read_b64_tr_b16 v[44:45], v12 offset:6144
    s_waitcnt lgkmcnt(6)
    v_mfma_f32_32x32x16_bf16 v[120:135], v[24:27], v[20:23], v[120:135]
    ds_read_b64_tr_b16 v[46:47], v12 offset:7680
    ds_read_b128 v[40:43], v9 offset:4096
    v_mfma_f32_16x16x32_bf16 v[60:63], v[56:59], v[24:27], v[60:63]
    s_waitcnt lgkmcnt(6)
    v_mfma_f32_32x32x16_bf16 v[88:103], v[28:31], v[16:19], v[88:103]
    ds_read_b64_tr_b16 v[48:49], v13 offset:6144
    ds_read_b64_tr_b16 v[50:51], v13 offset:7680
    v_mfma_f32_32x32x16_bf16 v[136:151], v[28:31], v[20:23], v[136:151]
    ds_read_b64_tr_b16 v[52:53], v14 offset:6144
    ds_read_b64_tr_b16 v[54:55], v14 offset:7680
    v_mfma_f32_16x16x32_bf16 v[64:67], v[56:59], v[28:31], v[64:67]
    s_waitcnt lgkmcnt(8)
    v_mfma_f32_32x32x16_bf16 v[104:119], v[32:35], v[16:19], v[104:119]
    v_mfma_f32_32x32x16_bf16 v[152:167], v[32:35], v[20:23], v[152:167]
    v_mfma_f32_16x16x32_bf16 v[68:71], v[56:59], v[32:35], v[68:71]
    s_waitcnt lgkmcnt(5)
    v_mfma_f32_32x32x16_bf16 v[72:87], v[44:47], v[36:39], v[72:87]
    ds_read_b128 v[16:19], v10
    ds_read_b64_tr_b16 v[24:25], v12 offset:12288
    s_waitcnt lgkmcnt(6)
    v_mfma_f32_32x32x16_bf16 v[120:135], v[44:47], v[40:43], v[120:135]
    ds_read_b64_tr_b16 v[26:27], v12 offset:13824
    ds_read_b128 v[20:23], v10 offset:4096
    s_waitcnt lgkmcnt(6)
    v_mfma_f32_32x32x16_bf16 v[88:103], v[48:51], v[36:39], v[88:103]
    ds_read_b64_tr_b16 v[28:29], v13 offset:12288
    ds_read_b64_tr_b16 v[30:31], v13 offset:13824
    v_mfma_f32_32x32x16_bf16 v[136:151], v[48:51], v[40:43], v[136:151]
    ds_read_b64_tr_b16 v[32:33], v14 offset:12288
    ds_read_b64_tr_b16 v[34:35], v14 offset:13824
    s_waitcnt lgkmcnt(8)
    v_mfma_f32_32x32x16_bf16 v[104:119], v[52:55], v[36:39], v[104:119]
    v_mfma_f32_32x32x16_bf16 v[152:167], v[52:55], v[40:43], v[152:167]
    s_waitcnt lgkmcnt(5)
    v_mfma_f32_32x32x16_bf16 v[72:87], v[24:27], v[16:19], v[72:87]
    ds_read_b128 v[36:39], v11
    ds_read_b64_tr_b16 v[44:45], v12 offset:18432
    ds_read_b64_tr_b16 v[46:47], v12 offset:19968
    s_waitcnt lgkmcnt(7)
    v_mfma_f32_32x32x16_bf16 v[120:135], v[24:27], v[20:23], v[120:135]
    ds_read_b128 v[40:43], v11 offset:4096
    ds_read_b64_tr_b16 v[48:49], v13 offset:18432
    ds_read_b64_tr_b16 v[50:51], v13 offset:19968
    v_mfma_f32_16x16x32_bf16 v[60:63], v[56:59], v[24:27], v[60:63]
    s_waitcnt lgkmcnt(8)
    v_mfma_f32_32x32x16_bf16 v[88:103], v[28:31], v[16:19], v[88:103]
    ds_read_b64_tr_b16 v[52:53], v14 offset:18432
    ds_read_b64_tr_b16 v[54:55], v14 offset:19968
    s_cmp_eq_u32 s36, 81920
    s_cselect_b32 s42, 4294885376, s49
    s_add_u32 s36, s36, s42
    v_mfma_f32_32x32x16_bf16 v[136:151], v[28:31], v[20:23], v[136:151]
    v_add_u32 v8, s42, v8
    v_add_u32 v12, s42, v12
    v_add_u32 v13, s42, v13
    v_add_u32 v14, s42, v14
    v_add_u32 v9, s42, v9
    v_mfma_f32_16x16x32_bf16 v[64:67], v[56:59], v[28:31], v[64:67]
    s_waitcnt lgkmcnt(8)
    v_mfma_f32_32x32x16_bf16 v[104:119], v[32:35], v[16:19], v[104:119]
    v_add_u32 v10, s42, v10
    v_add_u32 v11, s42, v11
    s_add_u32 s35, s35, 1
    s_cmp_lt_u32 s35, 10
    s_cbranch_scc1 AC_loop_h0
    s_waitcnt lgkmcnt(0)
    v_mfma_f32_16x16x32_bf16 v[68:71], v[56:59], v[32:35], v[68:71]
    v_mfma_f32_32x32x16_bf16 v[152:167], v[32:35], v[20:23], v[152:167]
    s_branch AC_fin_h
.p2align 6
AC_loop_h1:
    s_waitcnt lgkmcnt(0)
    v_mfma_f32_32x32x16_bf16 v[152:167], v[32:35], v[20:23], v[152:167]
AC_ent_h1:
    s_barrier
    v_mfma_f32_32x32x16_bf16 v[72:87], v[44:47], v[36:39], v[72:87]
    ds_read_b128 v[16:19], v8
    ds_read_b64_tr_b16 v[24:25], v12 offset:0
    v_mfma_f32_32x32x16_bf16 v[120:135], v[44:47], v[40:43], v[120:135]
    ds_read_b64_tr_b16 v[26:27], v12 offset:1536
    ds_read_b128 v[20:23], v8 offset:4096
    v_mfma_f32_16x16x32_bf16 v[60:63], v[56:59], v[44:47], v[60:63]
    v_mfma_f32_32x32x16_bf16 v[88:103], v[48:51], v[36:39], v[88:103]
    ds_read_b64_tr_b16 v[28:29], v13 offset:0
    ds_read_b64_tr_b16 v[30:31], v13 offset:1536
    v_mfma_f32_32x32x16_bf16 v[136:151], v[48:51], v[40:43], v[136:151]
    ds_read_b64_tr_b16 v[32:33], v14 offset:0
    ds_read_b64_tr_b16 v[34:35], v14 offset:1536
    v_mfma_f32_16x16x32_bf16 v[64:67], v[56:59], v[48:51], v[64:67]
    v_mfma_f32_32x32x16_bf16 v[104:119], v[52:55], v[36:39], v[104:119]
    v_mfma_f32_32x32x16_bf16 v[152:167], v[52:55], v[40:43], v[152:167]
    v_mfma_f32_16x16x32_bf16 v[68:71], v[56:59], v[52:55], v[68:71]
    s_waitcnt lgkmcnt(5)
    v_mfma_f32_32x32x16_bf16 v[72:87], v[24:27], v[16:19], v[72:87]
    ds_read_b128 v[36:39], v9
    ds_read_b64_tr_b16 v[44:45], v12 offset:6144
    s_waitcnt lgkmcnt(6)
    v_mfma_f32_32x32x16_bf16 v[120:135], v[24:27], v[20:23], v[120:135]
    ds_read_b64_tr_b16 v[46:47], v12 offset:7680
    ds_read_b128 v[40:43], v9 offset:4096
    s_waitcnt lgkmcnt(6)
    v_mfma_f32_32x32x16_bf16 v[88:103], v[28:31], v[16:19], v[88:103]
    ds_read_b64_tr_b16 v[48:49], v13 offset:6144
    ds_read_b64_tr_b16 v[50:51], v13 offset:7680
    v_mfma_f32_32x32x16_bf16 v[136:151], v[28:31], v[20:23], v[136:151]
    ds_read_b64_tr_b16 v[52:53], v14 offset:6144
    ds_read_b64_tr_b16 v[54:55], v14 offset:7680
    s_waitcnt lgkmcnt(8)
    v_mfma_f32_32x32x16_bf16 v[104:119], v[32:35], v[16:19], v[104:119]
    v_mfma_f32_32x32x16_bf16 v[152:167], v[32:35], v[20:23], v[152:167]
    s_waitcnt lgkmcnt(5)
    v_mfma_f32_32x32x16_bf16 v[72:87], v[44:47], v[36:39], v[72:87]
    ds_read_b128 v[16:19], v10
    ds_read_b64_tr_b16 v[24:25], v12 offset:12288
    s_waitcnt lgkmcnt(6)
    v_mfma_f32_32x32x16_bf16 v[120:135], v[44:47], v[40:43], v[120:135]
    ds_read_b64_tr_b16 v[26:27], v12 offset:13824
    ds_read_b128 v[20:23], v10 offset:4096
    v_mfma_f32_16x16x32_bf16 v[60:63], v[56:59], v[44:47], v[60:63]
    s_waitcnt lgkmcnt(6)
    v_mfma_f32_32x32x16_bf16 v[88:103], v[48:51], v[36:39], v[88:103]
    ds_read_b64_tr_b16 v[28:29], v13 offset:12288
    ds_read_b64_tr_b16 v[30:31], v13 offset:13824
    v_mfma_f32_32x32x16_bf16 v[136:151], v[48:51], v[40:43], v[136:151]
    ds_read_b64_tr_b16 v[32:33], v14 offset:12288
    ds_read_b64_tr_b16 v[34:35], v14 offset:13824
    v_mfma_f32_16x16x32_bf16 v[64:67], v[56:59], v[48:51], v[64:67]
    s_waitcnt lgkmcnt(8)
    v_mfma_f32_32x32x16_bf16 v[104:119], v[52:55], v[36:39], v[104:119]
    v_mfma_f32_32x32x16_bf16 v[152:167], v[52:55], v[40:43], v[152:167]
    v_mfma_f32_16x16x32_bf16 v[68:71], v[56:59], v[52:55], v[68:71]
    s_waitcnt lgkmcnt(5)
    v_mfma_f32_32x32x16_bf16 v[72:87], v[24:27], v[16:19], v[72:87]
    ds_read_b128 v[36:39], v11
    ds_read_b64_tr_b16 v[44:45], v12 offset:18432
    ds_read_b64_tr_b16 v[46:47], v12 offset:19968
    s_waitcnt lgkmcnt(7)
    v_mfma_f32_32x32x16_bf16 v[120:135], v[24:27], v[20:23], v[120:135]
    ds_read_b128 v[40:43], v11 offset:4096
    ds_read_b64_tr_b16 v[48:49], v13 offset:18432
    ds_read_b64_tr_b16 v[50:51], v13 offset:19968
    s_waitcnt lgkmcnt(8)
    v_mfma_f32_32x32x16_bf16 v[88:103], v[28:31], v[16:19], v[88:103]
    ds_read_b64_tr_b16 v[52:53], v14 offset:18432
    ds_read_b64_tr_b16 v[54:55], v14 offset:19968
    s_cmp_eq_u32 s36, 81920
    s_cselect_b32 s42, 4294885376, s49
    s_add_u32 s36, s36, s42
    v_mfma_f32_32x32x16_bf16 v[136:151], v[28:31], v[20:23], v[136:151]
    v_add_u32 v8, s42, v8
    v_add_u32 v12, s42, v12
    v_add_u32 v13, s42, v13
    v_add_u32 v14, s42, v14
    v_add_u32 v9, s42, v9
    s_waitcnt lgkmcnt(8)
    v_mfma_f32_32x32x16_bf16 v[104:119], v[32:35], v[16:19], v[104:119]
    v_add_u32 v10, s42, v10
    v_add_u32 v11, s42, v11
    s_add_u32 s35, s35, 1
    s_cmp_lt_u32 s35, 10
    s_cbranch_scc1 AC_loop_h1
    s_waitcnt lgkmcnt(0)
    v_mfma_f32_32x32x16_bf16 v[152:167], v[32:35], v[20:23], v[152:167]
    v_mfma_f32_16x16x32_bf16 v[60:63], v[56:59], v[44:47], v[60:63]
    v_mfma_f32_16x16x32_bf16 v[64:67], v[56:59], v[48:51], v[64:67]
    v_mfma_f32_16x16x32_bf16 v[68:71], v[56:59], v[52:55], v[68:71]
AC_fin_h:
    v_and_b32 v1, 31, v0
    s_lshl_b32 s45, s40, 8
    s_add_u32 s45, s45, 159744
    v_lshl_add_u32 v2, v1, 2, s45
    v_mfma_f32_32x32x16_bf16 v[72:87], v[44:47], v[36:39], v[72:87]
    v_mov_b32 v16, 0
    v_mov_b32 v17, 0
    v_mov_b32 v18, 0
    v_mov_b32 v19, 0
    v_mov_b32 v20, 0
    v_mfma_f32_32x32x16_bf16 v[120:135], v[44:47], v[40:43], v[120:135]
    v_mov_b32 v21, 0
    v_mov_b32 v22, 0
    v_mov_b32 v23, 0
    v_mov_b32 v24, 0
    v_mov_b32 v25, 0
    v_mfma_f32_32x32x16_bf16 v[88:103], v[48:51], v[36:39], v[88:103]
    v_mov_b32 v26, 0
    v_mov_b32 v27, 0
    v_mov_b32 v28, 0
    v_mov_b32 v29, 0
    v_mov_b32 v30, 0
    v_mfma_f32_32x32x16_bf16 v[136:151], v[48:51], v[40:43], v[136:151]
    v_mov_b32 v31, 0
    v_mov_b32 v32, 0
    v_mov_b32 v33, 0
    v_mov_b32 v34, 0
    v_mov_b32 v35, 0
    v_mfma_f32_32x32x16_bf16 v[104:119], v[52:55], v[36:39], v[104:119]
    s_mov_b32 exec_hi, 0
    ds_read_b32 v16, v2
    ds_read_b32 v20, v2 offset:128
    s_mov_b32 exec_hi, -1
    ds_read_b32 v4, v2 offset:512
    v_mfma_f32_32x32x16_bf16 v[152:167], v[52:55], v[40:43], v[152:167]
    ds_read_b32 v6, v2 offset:640
    s_mul_i32 s46, s41, 768
    s_add_u32 s46, s46, 160768
    v_lshl_add_u32 v3, v1, 3, s46
    s_lshl_b32 s46, s40, 2
    v_add_u32 v7, s46, v3
    ds_write_b32 v7, v60 offset:0
    ds_write_b32 v7, v64 offset:256
    ds_write_b32 v7, v68 offset:512
    s_mov_b64 exec, 1
    v_mov_b32 v8, 162828
    v_mov_b32 v9, 1
    ds_add_u32 v8, v9
    s_mov_b64 exec, -1
    v_mov_b32 v8, 162828
    s_mov_b32 s35, 800000
AC_sync_h:
    ds_read_b32 v9, v8
    s_waitcnt lgkmcnt(0)
    v_readfirstlane_b32 s36, v9
    s_nop 0
    s_cmp_ge_u32 s36, 4
    s_cbranch_scc1 AC_sync_h_ok
    s_sleep 1
    s_sub_u32 s35, s35, 1
    s_cmp_lg_u32 s35, 0
    s_cbranch_scc1 AC_sync_h
AC_sync_h_ok:
    ds_read_b64 v[60:61], v3 offset:0
    ds_read_b64 v[64:65], v3 offset:256
    ds_read_b64 v[68:69], v3 offset:512
    s_waitcnt lgkmcnt(0)
    v_add_f32 v60, v60, v61
    v_add_f32 v64, v64, v65
    v_add_f32 v68, v68, v69
    v_cvt_pk_bf16_f32 v61, v60, v60
    v_cvt_pk_bf16_f32 v65, v64, v64
    v_cvt_pk_bf16_f32 v69, v68, v68
    v_lshlrev_b32 v61, 16, v61
    v_lshlrev_b32 v65, 16, v65
    v_lshlrev_b32 v69, 16, v69
    v_sub_f32 v61, v60, v61
    v_sub_f32 v65, v64, v65
    v_sub_f32 v69, v68, v69
    v_cvt_pk_bf16_f32 v24, v60, v61
    v_cvt_pk_bf16_f32 v28, v64, v65
    v_cvt_pk_bf16_f32 v32, v68, v69
    s_waitcnt lgkmcnt(0)
    v_mfma_f32_32x32x16_bf16 v[72:87], v[24:27], v[16:19], v[72:87]
    v_mfma_f32_32x32x16_bf16 v[88:103], v[28:31], v[16:19], v[88:103]
    v_mfma_f32_32x32x16_bf16 v[104:119], v[32:35], v[16:19], v[104:119]
    v_mfma_f32_32x32x16_bf16 v[120:135], v[24:27], v[20:23], v[120:135]
    v_mfma_f32_32x32x16_bf16 v[136:151], v[28:31], v[20:23], v[136:151]
    v_mfma_f32_32x32x16_bf16 v[152:167], v[32:35], v[20:23], v[152:167]
    v_lshlrev_b32 v1, 4, v0
    s_nop 5
    v_mul_f32 v72, v4, v72
    v_mul_f32 v73, v4, v73
    v_mul_f32 v74, v4, v74
    v_mul_f32 v75, v4, v75
    v_mul_f32 v76, v4, v76
    v_mul_f32 v77, v4, v77
    v_mul_f32 v78, v4, v78
    v_mul_f32 v79, v4, v79
    v_mul_f32 v80, v4, v80
    v_mul_f32 v81, v4, v81
    v_mul_f32 v82, v4, v82
    v_mul_f32 v83, v4, v83
    v_mul_f32 v84, v4, v84
    v_mul_f32 v85, v4, v85
    v_mul_f32 v86, v4, v86
    v_mul_f32 v87, v4, v87
    v_cvt_pk_bf16_f32 v72, v72, v73
    v_cvt_pk_bf16_f32 v73, v74, v75
    v_cvt_pk_bf16_f32 v74, v76, v77
    v_cvt_pk_bf16_f32 v75, v78, v79
    v_cvt_pk_bf16_f32 v76, v80, v81
    v_cvt_pk_bf16_f32 v77, v82, v83
    v_cvt_pk_bf16_f32 v78, v84, v85
    v_cvt_pk_bf16_f32 v79, v86, v87
    v_pk_max_i16 v72, v72, 0
    v_pk_max_i16 v73, v73, 0
    v_pk_max_i16 v74, v74, 0
    v_pk_max_i16 v75, v75, 0
    v_pk_max_i16 v76, v76, 0
    v_pk_max_i16 v77, v77, 0
    v_pk_max_i16 v78, v78, 0
    v_pk_max_i16 v79, v79, 0
    v_mul_f32 v88, v4, v88
    v_mul_f32 v89, v4, v89
    v_mul_f32 v90, v4, v90
    v_mul_f32 v91, v4, v91
    v_mul_f32 v92, v4, v92
    v_mul_f32 v93, v4, v93
    v_mul_f32 v94, v4, v94
    v_mul_f32 v95, v4, v95
    v_mul_f32 v96, v4, v96
    v_mul_f32 v97, v4, v97
    v_mul_f32 v98, v4, v98
    v_mul_f32 v99, v4, v99
    v_mul_f32 v100, v4, v100
    v_mul_f32 v101, v4, v101
    v_mul_f32 v102, v4, v102
    v_mul_f32 v103, v4, v103
    v_cvt_pk_bf16_f32 v80, v88, v89
    v_cvt_pk_bf16_f32 v81, v90, v91
    v_cvt_pk_bf16_f32 v82, v92, v93
    v_cvt_pk_bf16_f32 v83, v94, v95
    v_cvt_pk_bf16_f32 v84, v96, v97
    v_cvt_pk_bf16_f32 v85, v98, v99
    v_cvt_pk_bf16_f32 v86, v100, v101
    v_cvt_pk_bf16_f32 v87, v102, v103
    v_pk_max_i16 v80, v80, 0
    v_pk_max_i16 v81, v81, 0
    v_pk_max_i16 v82, v82, 0
    v_pk_max_i16 v83, v83, 0
    v_pk_max_i16 v84, v84, 0
    v_pk_max_i16 v85, v85, 0
    v_pk_max_i16 v86, v86, 0
    v_pk_max_i16 v87, v87, 0
    v_pk_mul_f32 v[104:105], v[104:105], v[4:5] op_sel_hi:[1,0]
    v_pk_mul_f32 v[106:107], v[106:107], v[4:5] op_sel_hi:[1,0]
    v_pk_mul_f32 v[108:109], v[108:109], v[4:5] op_sel_hi:[1,0]
    v_pk_mul_f32 v[110:111], v[110:111], v[4:5] op_sel_hi:[1,0]
    v_pk_mul_f32 v[112:113], v[112:113], v[4:5] op_sel_hi:[1,0]
    v_pk_mul_f32 v[114:115], v[114:115], v[4:5] op_sel_hi:[1,0]
    v_pk_mul_f32 v[116:117], v[116:117], v[4:5] op_sel_hi:[1,0]
    v_pk_mul_f32 v[118:119], v[118:119], v[4:5] op_sel_hi:[1,0]
    v_cvt_pk_bf16_f32 v88, v104, v105
    v_cvt_pk_bf16_f32 v89, v106, v107
    v_cvt_pk_bf16_f32 v90, v108, v109
    v_cvt_pk_bf16_f32 v91, v110, v111
    v_cvt_pk_bf16_f32 v92, v112, v113
    v_cvt_pk_bf16_f32 v93, v114, v115
    v_cvt_pk_bf16_f32 v94, v116, v117
    v_cvt_pk_bf16_f32 v95, v118, v119
    v_pk_max_i16 v88, v88, 0
    v_pk_max_i16 v89, v89, 0
    v_pk_max_i16 v90, v90, 0
    v_pk_max_i16 v91, v91, 0
    v_pk_max_i16 v92, v92, 0
    v_pk_max_i16 v93, v93, 0
    v_pk_max_i16 v94, v94, 0
    v_pk_max_i16 v95, v95, 0
    v_pk_mul_f32 v[120:121], v[120:121], v[6:7] op_sel_hi:[1,0]
    v_pk_mul_f32 v[122:123], v[122:123], v[6:7] op_sel_hi:[1,0]
    v_pk_mul_f32 v[124:125], v[124:125], v[6:7] op_sel_hi:[1,0]
    v_pk_mul_f32 v[126:127], v[126:127], v[6:7] op_sel_hi:[1,0]
    v_pk_mul_f32 v[128:129], v[128:129], v[6:7] op_sel_hi:[1,0]
    v_pk_mul_f32 v[130:131], v[130:131], v[6:7] op_sel_hi:[1,0]
    v_pk_mul_f32 v[132:133], v[132:133], v[6:7] op_sel_hi:[1,0]
    v_pk_mul_f32 v[134:135], v[134:135], v[6:7] op_sel_hi:[1,0]
    v_cvt_pk_bf16_f32 v96, v120, v121
    v_cvt_pk_bf16_f32 v97, v122, v123
    v_cvt_pk_bf16_f32 v98, v124, v125
    v_cvt_pk_bf16_f32 v99, v126, v127
    v_cvt_pk_bf16_f32 v100, v128, v129
    v_cvt_pk_bf16_f32 v101, v130, v131
    v_cvt_pk_bf16_f32 v102, v132, v133
    v_cvt_pk_bf16_f32 v103, v134, v135
    v_pk_max_i16 v96, v96, 0
    v_pk_max_i16 v97, v97, 0
    v_pk_max_i16 v98, v98, 0
    v_pk_max_i16 v99, v99, 0
    v_pk_max_i16 v100, v100, 0
    v_pk_max_i16 v101, v101, 0
    v_pk_max_i16 v102, v102, 0
    v_pk_max_i16 v103, v103, 0
    v_pk_mul_f32 v[136:137], v[136:137], v[6:7] op_sel_hi:[1,0]
    v_pk_mul_f32 v[138:139], v[138:139], v[6:7] op_sel_hi:[1,0]
    v_pk_mul_f32 v[140:141], v[140:141], v[6:7] op_sel_hi:[1,0]
    v_pk_mul_f32 v[142:143], v[142:143], v[6:7] op_sel_hi:[1,0]
    v_pk_mul_f32 v[144:145], v[144:145], v[6:7] op_sel_hi:[1,0]
    v_pk_mul_f32 v[146:147], v[146:147], v[6:7] op_sel_hi:[1,0]
    v_pk_mul_f32 v[148:149], v[148:149], v[6:7] op_sel_hi:[1,0]
    v_pk_mul_f32 v[150:151], v[150:151], v[6:7] op_sel_hi:[1,0]
    v_cvt_pk_bf16_f32 v104, v136, v137
    v_cvt_pk_bf16_f32 v105, v138, v139
    v_cvt_pk_bf16_f32 v106, v140, v141
    v_cvt_pk_bf16_f32 v107, v142, v143
    v_cvt_pk_bf16_f32 v108, v144, v145
    v_cvt_pk_bf16_f32 v109, v146, v147
    v_cvt_pk_bf16_f32 v110, v148, v149
    v_cvt_pk_bf16_f32 v111, v150, v151
    v_pk_max_i16 v104, v104, 0
    v_pk_max_i16 v105, v105, 0
    v_pk_max_i16 v106, v106, 0
    v_pk_max_i16 v107, v107, 0
    v_pk_max_i16 v108, v108, 0
    v_pk_max_i16 v109, v109, 0
    v_pk_max_i16 v110, v110, 0
    v_pk_max_i16 v111, v111, 0
    v_pk_mul_f32 v[152:153], v[152:153], v[6:7] op_sel_hi:[1,0]
    v_pk_mul_f32 v[154:155], v[154:155], v[6:7] op_sel_hi:[1,0]
    v_pk_mul_f32 v[156:157], v[156:157], v[6:7] op_sel_hi:[1,0]
    v_pk_mul_f32 v[158:159], v[158:159], v[6:7] op_sel_hi:[1,0]
    v_pk_mul_f32 v[160:161], v[160:161], v[6:7] op_sel_hi:[1,0]
    v_pk_mul_f32 v[162:163], v[162:163], v[6:7] op_sel_hi:[1,0]
    v_pk_mul_f32 v[164:165], v[164:165], v[6:7] op_sel_hi:[1,0]
    v_pk_mul_f32 v[166:167], v[166:167], v[6:7] op_sel_hi:[1,0]
    v_cvt_pk_bf16_f32 v112, v152, v153
    v_cvt_pk_bf16_f32 v113, v154, v155
    v_cvt_pk_bf16_f32 v114, v156, v157
    v_cvt_pk_bf16_f32 v115, v158, v159
    v_cvt_pk_bf16_f32 v116, v160, v161
    v_cvt_pk_bf16_f32 v117, v162, v163
    v_cvt_pk_bf16_f32 v118, v164, v165
    v_cvt_pk_bf16_f32 v119, v166, v167
    v_pk_max_i16 v112, v112, 0
    v_pk_max_i16 v113, v113, 0
    v_pk_max_i16 v114, v114, 0
    v_pk_max_i16 v115, v115, 0
    v_pk_max_i16 v116, v116, 0
    v_pk_max_i16 v117, v117, 0
    v_pk_max_i16 v118, v118, 0
    v_pk_max_i16 v119, v119, 0
    s_mov_b32 s53, s47
    s_branch F_gemm
A_ckv:
    s_mul_i32 s47, s47, 3072
    s_add_u32 s47, s47, 10485760
    s_cmp_eq_u32 s41, 1
    s_cbranch_scc1 A_cv
    v_and_b32 v1, 31, v0
    v_lshrrev_b32 v2, 5, v0
    v_bfe_u32 v3, v0, 1, 3
    v_xor_b32 v3, v3, v2
    v_lshlrev_b32 v3, 4, v3
    v_lshlrev_b32 v1, 7, v1
    s_lshl_b32 s45, s40, 13
    s_add_u32 s45, s45, 81920
    v_add_u32 v1, s45, v1
    v_xor_b32 v4, 0, v3
    v_add_u32 v8, v1, v4
    v_xor_b32 v4, 32, v3
    v_add_u32 v9, v1, v4
    v_xor_b32 v4, 64, v3
    v_add_u32 v10, v1, v4
    v_xor_b32 v4, 96, v3
    v_add_u32 v11, v1, v4
    v_lshrrev_b32 v1, 5, v0
    v_bfe_u32 v2, v0, 2, 2
    v_lshl_add_u32 v1, v1, 3, v2
    v_mul_u32_u24 v1, 64, v1
    v_bfe_u32 v3, v0, 4, 1
    v_lshl_add_u32 v1, v3, 5, v1
    v_and_b32 v3, 3, v0
    v_lshl_add_u32 v1, v3, 3, v1
    v_add_u32 v1, 98304, v1
    s_lshl_b32 s45, s41, 12
    v_add_u32 v12, s45, v1
    v_lshrrev_b32 v1, 2, v0
    v_lshrrev_b32 v2, 4, v0
    v_xor_b32 v1, v1, v2
    v_and_b32 v1, 1, v1
    v_subrev_u32 v1, 1, v1
    v_and_b32 v56, 0x3f803f80, v1
    v_and_b32 v57, 0x3f803f80, v1
    v_and_b32 v58, 0x3f803f80, v1
    v_and_b32 v59, 0x3f803f80, v1
    v_mov_b32 v36, 0
    v_mov_b32 v37, 0
    v_mov_b32 v38, 0
    v_mov_b32 v39, 0
    v_mov_b32 v40, 0
    v_mov_b32 v41, 0
    v_mov_b32 v42, 0
    v_mov_b32 v43, 0
    v_mov_b32 v44, 0
    v_mov_b32 v45, 0
    v_mov_b32 v46, 0
    v_mov_b32 v47, 0
    v_mfma_f32_32x32x16_bf16 v[72:87], v[36:39], v[36:39], 0
    v_mfma_f32_32x32x16_bf16 v[88:103], v[36:39], v[36:39], 0
    v_mfma_f32_16x16x32_bf16 v[60:63], v[36:39], v[36:39], 0
    s_mov_b32 s35, 0
    s_mov_b32 s36, 81920
    s_cmp_eq_u32 s36, 81920
    s_cselect_b32 s42, 4294885376, s49
    s_add_u32 s36, s36, s42
    v_add_u32 v8, s42, v8
    v_add_u32 v12, s42, v12
    v_add_u32 v9, s42, v9
    v_add_u32 v10, s42, v10
    v_add_u32 v11, s42, v11
    s_branch AC_ent_kv0
.p2align 6
AC_loop_kv0:
    s_waitcnt lgkmcnt(0)
    v_mfma_f32_16x16x32_bf16 v[60:63], v[56:59], v[24:27], v[60:63]
    v_mfma_f32_32x32x16_bf16 v[88:103], v[24:27], v[20:23], v[88:103]
AC_ent_kv0:
    s_barrier
    v_mfma_f32_32x32x16_bf16 v[72:87], v[44:47], v[36:39], v[72:87]
    ds_read_b128 v[16:19], v8
    ds_read_b64_tr_b16 v[24:25], v12 offset:0
    v_mfma_f32_32x32x16_bf16 v[88:103], v[44:47], v[40:43], v[88:103]
    ds_read_b64_tr_b16 v[26:27], v12 offset:256
    ds_read_b128 v[20:23], v8 offset:4096
    v_mfma_f32_16x16x32_bf16 v[60:63], v[56:59], v[44:47], v[60:63]
    s_waitcnt lgkmcnt(1)
    v_mfma_f32_32x32x16_bf16 v[72:87], v[24:27], v[16:19], v[72:87]
    ds_read_b128 v[36:39], v9
    ds_read_b64_tr_b16 v[44:45], v12 offset:1024
    s_waitcnt lgkmcnt(2)
    v_mfma_f32_32x32x16_bf16 v[88:103], v[24:27], v[20:23], v[88:103]
    ds_read_b64_tr_b16 v[46:47], v12 offset:1280
    ds_read_b128 v[40:43], v9 offset:4096
    v_mfma_f32_16x16x32_bf16 v[60:63], v[56:59], v[24:27], v[60:63]
    s_waitcnt lgkmcnt(1)
    v_mfma_f32_32x32x16_bf16 v[72:87], v[44:47], v[36:39], v[72:87]
    ds_read_b128 v[16:19], v10
    ds_read_b64_tr_b16 v[24:25], v12 offset:2048
    s_waitcnt lgkmcnt(2)
    v_mfma_f32_32x32x16_bf16 v[88:103], v[44:47], v[40:43], v[88:103]
    ds_read_b64_tr_b16 v[26:27], v12 offset:2304
    ds_read_b128 v[20:23], v10 offset:4096
    v_mfma_f32_16x16x32_bf16 v[60:63], v[56:59], v[44:47], v[60:63]
    s_waitcnt lgkmcnt(1)
    v_mfma_f32_32x32x16_bf16 v[72:87], v[24:27], v[16:19], v[72:87]
    ds_read_b128 v[36:39], v11
    ds_read_b64_tr_b16 v[44:45], v12 offset:3072
    ds_read_b64_tr_b16 v[46:47], v12 offset:3328
    ds_read_b128 v[40:43], v11 offset:4096
    s_cmp_eq_u32 s36, 81920
    s_cselect_b32 s42, 4294885376, s49
    s_add_u32 s36, s36, s42
    v_add_u32 v8, s42, v8
    v_add_u32 v12, s42, v12
    v_add_u32 v9, s42, v9
    v_add_u32 v10, s42, v10
    v_add_u32 v11, s42, v11
    s_add_u32 s35, s35, 1
    s_cmp_lt_u32 s35, 10
    s_cbranch_scc1 AC_loop_kv0
    s_waitcnt lgkmcnt(0)
    v_mfma_f32_16x16x32_bf16 v[60:63], v[56:59], v[24:27], v[60:63]
    v_mfma_f32_32x32x16_bf16 v[88:103], v[24:27], v[20:23], v[88:103]
    v_mfma_f32_16x16x32_bf16 v[60:63], v[56:59], v[44:47], v[60:63]
AC_fin_kv:
    v_and_b32 v1, 31, v0
    s_lshl_b32 s45, s40, 8
    s_add_u32 s45, s45, 159744
    v_lshl_add_u32 v2, v1, 2, s45
    v_mfma_f32_32x32x16_bf16 v[72:87], v[44:47], v[36:39], v[72:87]
    v_mov_b32 v16, 0
    v_mov_b32 v17, 0
    v_mov_b32 v18, 0
    v_mov_b32 v19, 0
    v_mov_b32 v20, 0
    v_mfma_f32_32x32x16_bf16 v[88:103], v[44:47], v[40:43], v[88:103]
    v_mov_b32 v21, 0
    v_mov_b32 v22, 0
    v_mov_b32 v23, 0
    v_mov_b32 v24, 0
    v_mov_b32 v25, 0
    v_mov_b32 v26, 0
    v_mov_b32 v27, 0
    s_mov_b32 exec_hi, 0
    ds_read_b32 v16, v2
    ds_read_b32 v20, v2 offset:128
    s_mov_b32 exec_hi, -1
    ds_read_b32 v4, v2 offset:512
    ds_read_b32 v6, v2 offset:640
    v_cvt_pk_bf16_f32 v61, v60, v60
    v_lshlrev_b32 v61, 16, v61
    v_sub_f32 v61, v60, v61
    v_cvt_pk_bf16_f32 v24, v60, v61
    s_waitcnt lgkmcnt(0)
    s_nop 0
    v_mfma_f32_32x32x16_bf16 v[72:87], v[24:27], v[16:19], v[72:87]
    v_mfma_f32_32x32x16_bf16 v[88:103], v[24:27], v[20:23], v[88:103]
    v_lshlrev_b32 v1, 4, v0
    s_nop 9
    v_mul_f32 v72, v4, v72
    v_mul_f32 v73, v4, v73
    v_mul_f32 v74, v4, v74
    v_mul_f32 v75, v4, v75
    v_mul_f32 v76, v4, v76
    v_mul_f32 v77, v4, v77
    v_mul_f32 v78, v4, v78
    v_mul_f32 v79, v4, v79
    v_mul_f32 v80, v4, v80
    v_mul_f32 v81, v4, v81
    v_mul_f32 v82, v4, v82
    v_mul_f32 v83, v4, v83
    v_cvt_pk_bf16_f32 v72, v72, v73
    v_cvt_pk_bf16_f32 v73, v74, v75
    v_cvt_pk_bf16_f32 v74, v76, v77
    v_cvt_pk_bf16_f32 v75, v78, v79
    v_cvt_pk_bf16_f32 v16, v80, v81
    v_cvt_pk_bf16_f32 v17, v82, v83
    buffer_store_dwordx4 v[72:75], v1, s[12:15], s47 offen offset:0 sc1
    v_mul_f32 v88, v6, v88
    v_mul_f32 v89, v6, v89
    v_mul_f32 v90, v6, v90
    v_mul_f32 v91, v6, v91
    v_mul_f32 v92, v6, v92
    v_mul_f32 v93, v6, v93
    v_mul_f32 v94, v6, v94
    v_mul_f32 v95, v6, v95
    v_mul_f32 v96, v6, v96
    v_mul_f32 v97, v6, v97
    v_mul_f32 v98, v6, v98
    v_mul_f32 v99, v6, v99
    v_cvt_pk_bf16_f32 v88, v88, v89
    v_cvt_pk_bf16_f32 v89, v90, v91
    v_cvt_pk_bf16_f32 v90, v92, v93
    v_cvt_pk_bf16_f32 v91, v94, v95
    v_cvt_pk_bf16_f32 v18, v96, v97
    v_cvt_pk_bf16_f32 v19, v98, v99
    buffer_store_dwordx4 v[88:91], v1, s[12:15], s47 offen offset:1024 sc1
    s_mov_b32 exec_lo, 0
    v_mov_b32 v16, 0x3f80
    v_mov_b32 v17, 0
    v_mov_b32 v18, 0x3f80
    v_mov_b32 v19, 0
    s_mov_b32 exec_lo, -1
    buffer_store_dwordx4 v[16:19], v1, s[12:15], s47 offen offset:2048 sc1
    s_branch F_pub
A_cv:
    v_and_b32 v1, 31, v0
    v_lshrrev_b32 v2, 5, v0
    v_bfe_u32 v3, v0, 1, 3
    v_xor_b32 v3, v3, v2
    v_lshlrev_b32 v3, 4, v3
    v_lshlrev_b32 v1, 7, v1
    s_lshl_b32 s45, s40, 13
    s_add_u32 s45, s45, 81920
    v_add_u32 v1, s45, v1
    v_xor_b32 v4, 0, v3
    v_add_u32 v8, v1, v4
    v_xor_b32 v4, 32, v3
    v_add_u32 v9, v1, v4
    v_xor_b32 v4, 64, v3
    v_add_u32 v10, v1, v4
    v_xor_b32 v4, 96, v3
    v_add_u32 v11, v1, v4
    v_lshrrev_b32 v1, 5, v0
    v_bfe_u32 v2, v0, 2, 2
    v_lshl_add_u32 v1, v1, 3, v2
    v_mul_u32_u24 v1, 64, v1
    v_bfe_u32 v3, v0, 4, 1
    v_lshl_add_u32 v1, v3, 5, v1
    v_and_b32 v3, 3, v0
    v_lshl_add_u32 v1, v3, 3, v1
    v_add_u32 v1, 98304, v1
    s_lshl_b32 s45, s41, 12
    v_add_u32 v12, s45, v1
    v_lshrrev_b32 v1, 2, v0
    v_lshrrev_b32 v2, 4, v0
    v_xor_b32 v1, v1, v2
    v_and_b32 v1, 1, v1
    v_subrev_u32 v1, 1, v1
    v_and_b32 v56, 0x3f803f80, v1
    v_and_b32 v57, 0x3f803f80, v1
    v_and_b32 v58, 0x3f803f80, v1
    v_and_b32 v59, 0x3f803f80, v1
    v_mov_b32 v36, 0
    v_mov_b32 v37, 0
    v_mov_b32 v38, 0
    v_mov_b32 v39, 0
    v_mov_b32 v40, 0
    v_mov_b32 v41, 0
    v_mov_b32 v42, 0
    v_mov_b32 v43, 0
    v_mov_b32 v44, 0
    v_mov_b32 v45, 0
    v_mov_b32 v46, 0
    v_mov_b32 v47, 0
    v_mfma_f32_32x32x16_bf16 v[72:87], v[36:39], v[36:39], 0
    v_mfma_f32_32x32x16_bf16 v[88:103], v[36:39], v[36:39], 0
    v_mfma_f32_16x16x32_bf16 v[60:63], v[36:39], v[36:39], 0
    s_mov_b32 s35, 0
    s_mov_b32 s36, 81920
    s_cmp_eq_u32 s36, 81920
    s_cselect_b32 s42, 4294885376, s49
    s_add_u32 s36, s36, s42
    v_add_u32 v8, s42, v8
    v_add_u32 v12, s42, v12
    v_add_u32 v9, s42, v9
    v_add_u32 v10, s42, v10
    v_add_u32 v11, s42, v11
    s_branch AC_ent_kvv0
.p2align 6
AC_loop_kvv0:
    s_waitcnt lgkmcnt(0)
    v_mfma_f32_16x16x32_bf16 v[60:63], v[56:59], v[24:27], v[60:63]
    v_mfma_f32_32x32x16_bf16 v[88:103], v[20:23], v[24:27], v[88:103]
AC_ent_kvv0:
    s_barrier
    v_mfma_f32_32x32x16_bf16 v[72:87], v[36:39], v[44:47], v[72:87]
    ds_read_b128 v[16:19], v8
    ds_read_b64_tr_b16 v[24:25], v12 offset:0
    v_mfma_f32_32x32x16_bf16 v[88:103], v[40:43], v[44:47], v[88:103]
    ds_read_b64_tr_b16 v[26:27], v12 offset:256
    ds_read_b128 v[20:23], v8 offset:4096
    v_mfma_f32_16x16x32_bf16 v[60:63], v[56:59], v[44:47], v[60:63]
    s_waitcnt lgkmcnt(1)
    v_mfma_f32_32x32x16_bf16 v[72:87], v[16:19], v[24:27], v[72:87]
    ds_read_b128 v[36:39], v9
    ds_read_b64_tr_b16 v[44:45], v12 offset:1024
    s_waitcnt lgkmcnt(2)
    v_mfma_f32_32x32x16_bf16 v[88:103], v[20:23], v[24:27], v[88:103]
    ds_read_b64_tr_b16 v[46:47], v12 offset:1280
    ds_read_b128 v[40:43], v9 offset:4096
    v_mfma_f32_16x16x32_bf16 v[60:63], v[56:59], v[24:27], v[60:63]
    s_waitcnt lgkmcnt(1)
    v_mfma_f32_32x32x16_bf16 v[72:87], v[36:39], v[44:47], v[72:87]
    ds_read_b128 v[16:19], v10
    ds_read_b64_tr_b16 v[24:25], v12 offset:2048
    s_waitcnt lgkmcnt(2)
    v_mfma_f32_32x32x16_bf16 v[88:103], v[40:43], v[44:47], v[88:103]
    ds_read_b64_tr_b16 v[26:27], v12 offset:2304
    ds_read_b128 v[20:23], v10 offset:4096
    v_mfma_f32_16x16x32_bf16 v[60:63], v[56:59], v[44:47], v[60:63]
    s_waitcnt lgkmcnt(1)
    v_mfma_f32_32x32x16_bf16 v[72:87], v[16:19], v[24:27], v[72:87]
    ds_read_b128 v[36:39], v11
    ds_read_b64_tr_b16 v[44:45], v12 offset:3072
    ds_read_b64_tr_b16 v[46:47], v12 offset:3328
    ds_read_b128 v[40:43], v11 offset:4096
    s_cmp_eq_u32 s36, 81920
    s_cselect_b32 s42, 4294885376, s49
    s_add_u32 s36, s36, s42
    v_add_u32 v8, s42, v8
    v_add_u32 v12, s42, v12
    v_add_u32 v9, s42, v9
    v_add_u32 v10, s42, v10
    v_add_u32 v11, s42, v11
    s_add_u32 s35, s35, 1
    s_cmp_lt_u32 s35, 10
    s_cbranch_scc1 AC_loop_kvv0
    s_waitcnt lgkmcnt(0)
    v_mfma_f32_16x16x32_bf16 v[60:63], v[56:59], v[24:27], v[60:63]
    v_mfma_f32_32x32x16_bf16 v[88:103], v[20:23], v[24:27], v[88:103]
    v_mfma_f32_16x16x32_bf16 v[60:63], v[56:59], v[44:47], v[60:63]
AC_fin_kvv:
    v_and_b32 v1, 31, v0
    s_lshl_b32 s45, s40, 8
    s_add_u32 s45, s45, 159744
    v_lshl_add_u32 v2, v1, 2, s45
    v_mfma_f32_32x32x16_bf16 v[72:87], v[36:39], v[44:47], v[72:87]
    v_mov_b32 v16, 0
    v_mov_b32 v17, 0
    v_mov_b32 v18, 0
    v_mov_b32 v19, 0
    v_mov_b32 v20, 0
    v_mfma_f32_32x32x16_bf16 v[88:103], v[40:43], v[44:47], v[88:103]
    v_mov_b32 v21, 0
    v_mov_b32 v22, 0
    v_mov_b32 v23, 0
    v_mov_b32 v24, 0
    v_mov_b32 v25, 0
    v_mov_b32 v26, 0
    v_mov_b32 v27, 0
    s_mov_b32 exec_hi, 0
    ds_read_b32 v16, v2
    ds_read_b32 v20, v2 offset:128
    s_mov_b32 exec_hi, -1
    ds_read_b32 v4, v2 offset:512
    ds_read_b32 v6, v2 offset:640
    v_cvt_pk_bf16_f32 v61, v60, v60
    v_lshlrev_b32 v61, 16, v61
    v_sub_f32 v61, v60, v61
    v_cvt_pk_bf16_f32 v24, v60, v61
    s_waitcnt lgkmcnt(0)
    s_nop 0
    v_mfma_f32_32x32x16_bf16 v[72:87], v[16:19], v[24:27], v[72:87]
    v_mfma_f32_32x32x16_bf16 v[88:103], v[20:23], v[24:27], v[88:103]
    v_lshlrev_b32 v1, 4, v0
    v_lshrrev_b32 v6, 5, v0
    v_lshl_add_u32 v3, v6, 4, s45
    ds_read_b128 v[16:19], v3 offset:512
    ds_read_b128 v[20:23], v3 offset:544
    ds_read_b128 v[24:27], v3 offset:576
    ds_read_b128 v[28:31], v3 offset:608
    ds_read_b128 v[32:35], v3 offset:640
    ds_read_b128 v[36:39], v3 offset:672
    ds_read_b128 v[40:43], v3 offset:704
    ds_read_b128 v[44:47], v3 offset:736
    v_and_b32 v2, 31, v0
    v_mul_u32_u24 v6, 384, v6
    v_lshl_add_u32 v6, v2, 4, v6
    s_add_u32 s47, s47, 3072
    s_waitcnt lgkmcnt(0)
    v_mul_f32 v72, v16, v72
    v_mul_f32 v73, v17, v73
    v_mul_f32 v74, v18, v74
    v_mul_f32 v75, v19, v75
    v_mul_f32 v76, v20, v76
    v_mul_f32 v77, v21, v77
    v_mul_f32 v78, v22, v78
    v_mul_f32 v79, v23, v79
    v_mul_f32 v80, v24, v80
    v_mul_f32 v81, v25, v81
    v_mul_f32 v82, v26, v82
    v_mul_f32 v83, v27, v83
    v_mul_f32 v84, v28, v84
    v_mul_f32 v85, v29, v85
    v_mul_f32 v86, v30, v86
    v_mul_f32 v87, v31, v87
    v_cvt_pk_bf16_f32 v72, v72, v73
    v_cvt_pk_bf16_f32 v73, v74, v75
    v_cvt_pk_bf16_f32 v74, v76, v77
    v_cvt_pk_bf16_f32 v75, v78, v79
    v_cvt_pk_bf16_f32 v76, v80, v81
    v_cvt_pk_bf16_f32 v77, v82, v83
    v_cvt_pk_bf16_f32 v78, v84, v85
    v_cvt_pk_bf16_f32 v79, v86, v87
    s_mov_b32 exec_lo, 0x00100000
    s_mov_b32 exec_hi, 0x00100000
    v_mov_b32 v72, 0x3f803f80
    v_mov_b32 v73, 0x3f803f80
    v_mov_b32 v74, 0x3f803f80
    v_mov_b32 v75, 0x3f803f80
    v_mov_b32 v76, 0x3f803f80
    v_mov_b32 v77, 0x3f803f80
    v_mov_b32 v78, 0x3f803f80
    v_mov_b32 v79, 0x3f803f80
    s_mov_b32 exec_lo, 0x00e00000
    s_mov_b32 exec_hi, 0x00e00000
    v_mov_b32 v72, 0
    v_mov_b32 v73, 0
    v_mov_b32 v74, 0
    v_mov_b32 v75, 0
    v_mov_b32 v76, 0
    v_mov_b32 v77, 0
    v_mov_b32 v78, 0
    v_mov_b32 v79, 0
    s_mov_b32 exec_lo, 0x00ffffff
    s_mov_b32 exec_hi, 0x00ffffff
    buffer_store_dwordx4 v[72:75], v6, s[12:15], s47 offen offset:0 sc1
    buffer_store_dwordx4 v[76:79], v6, s[12:15], s47 offen offset:768 sc1
    s_mov_b64 exec, -1
    v_mul_f32 v88, v32, v88
    v_mul_f32 v89, v33, v89
    v_mul_f32 v90, v34, v90
    v_mul_f32 v91, v35, v91
    v_mul_f32 v92, v36, v92
    v_mul_f32 v93, v37, v93
    v_mul_f32 v94, v38, v94
    v_mul_f32 v95, v39, v95
    v_mul_f32 v96, v40, v96
    v_mul_f32 v97, v41, v97
    v_mul_f32 v98, v42, v98
    v_mul_f32 v99, v43, v99
    v_mul_f32 v100, v44, v100
    v_mul_f32 v101, v45, v101
    v_mul_f32 v102, v46, v102
    v_mul_f32 v103, v47, v103
    v_cvt_pk_bf16_f32 v88, v88, v89
    v_cvt_pk_bf16_f32 v89, v90, v91
    v_cvt_pk_bf16_f32 v90, v92, v93
    v_cvt_pk_bf16_f32 v91, v94, v95
    v_cvt_pk_bf16_f32 v92, v96, v97
    v_cvt_pk_bf16_f32 v93, v98, v99
    v_cvt_pk_bf16_f32 v94, v100, v101
    v_cvt_pk_bf16_f32 v95, v102, v103
    s_mov_b32 exec_lo, 0x00100000
    s_mov_b32 exec_hi, 0x00100000
    v_mov_b32 v88, 0x3f803f80
    v_mov_b32 v89, 0x3f803f80
    v_mov_b32 v90, 0x3f803f80
    v_mov_b32 v91, 0x3f803f80
    v_mov_b32 v92, 0x3f803f80
    v_mov_b32 v93, 0x3f803f80
    v_mov_b32 v94, 0x3f803f80
    v_mov_b32 v95, 0x3f803f80
    s_mov_b32 exec_lo, 0x00e00000
    s_mov_b32 exec_hi, 0x00e00000
    v_mov_b32 v88, 0
    v_mov_b32 v89, 0
    v_mov_b32 v90, 0
    v_mov_b32 v91, 0
    v_mov_b32 v92, 0
    v_mov_b32 v93, 0
    v_mov_b32 v94, 0
    v_mov_b32 v95, 0
    s_mov_b32 exec_lo, 0x00ffffff
    s_mov_b32 exec_hi, 0x00ffffff
    buffer_store_dwordx4 v[88:91], v6, s[12:15], s47 offen offset:1536 sc1
    buffer_store_dwordx4 v[92:95], v6, s[12:15], s47 offen offset:2304 sc1
    s_mov_b64 exec, -1
    s_branch F_pub
A_stats:
    s_sub_u32 s45, s34, 9
    s_cmp_lt_u32 s45, 5
    s_cselect_b32 s44, 0x3ea52b5c, 1.0
    v_lshlrev_b32 v1, 2, v0
    v_add_u32 v1, 162816, v1
    v_mov_b32 v2, 0
    ds_write_b32 v1, v2
    ds_write_b32 v1, v2 offset:256
    v_cmp_lt_u32 vcc, 6, v0
    s_nop 1
    v_cndmask_b32 v2, 0, 4, vcc
    ds_write_b32 v1, v2 offset:512
    s_waitcnt lgkmcnt(0)
    s_and_b32 s64, s2, 1
    s_lshl_b32 s64, s64, 3
    s_lshr_b32 s35, s2, 5
    s_add_u32 s64, s64, s35
    s_lshl_b32 s64, s64, 2
    s_bfe_u32 s35, s2, 0x20001
    s_add_u32 s64, s64, s35
    s_lshl_b32 s64, s64, 2
    s_bfe_u32 s35, s2, 0x20003
    s_add_u32 s64, s64, s35
    s_and_b32 s35, s64, 3
    s_lshl_b32 s35, s35, 3
    s_add_u32 s35, s35, s32
    s_mul_i32 s35, s35, 5
    v_lshrrev_b32 v2, 5, v0
    v_and_b32 v3, 31, v0
    v_lshlrev_b32 v3, 4, v3
    v_add_u32 v1, s35, v2
    v_lshrrev_b32 v130, 2, v1
    v_lshl_add_u32 v126, v130, 10, v3
    v_and_b32 v130, 1, v1
    v_lshl_add_u32 v126, v130, 9, v126
    v_bfe_u32 v130, v1, 1, 1
    v_lshl_add_u32 v126, v130, 3, v126
    v_add_u32 v1, s35, v2
    v_add_u32 v1, 2, v1
    v_lshrrev_b32 v130, 2, v1
    v_lshl_add_u32 v127, v130, 10, v3
    v_and_b32 v130, 1, v1
    v_lshl_add_u32 v127, v130, 9, v127
    v_bfe_u32 v130, v1, 1, 1
    v_lshl_add_u32 v127, v130, 3, v127
    v_mov_b32 v1, s35
    v_add_u32 v1, 4, v1
    v_lshrrev_b32 v130, 2, v1
    v_lshl_add_u32 v128, v130, 10, v3
    v_and_b32 v130, 1, v1
    v_lshl_add_u32 v128, v130, 9, v128
    v_bfe_u32 v130, v1, 1, 1
    v_lshl_add_u32 v128, v130, 3, v128
    v_lshlrev_b32 v136, 4, v0
    v_add_u32 v124, 135168, v136
    v_lshlrev_b32 v137, 2, v0
    v_add_u32 v137, 163072, v137
    v_cmp_eq_u32 vcc, 0, v0
    s_nop 1
    v_cndmask_b32 v138, 0, 1, vcc
    v_and_b32 v1, 31, v0
    v_min_u32 v1, 23, v1
    v_mul_u32_u24 v125, 384, v2
    v_lshl_add_u32 v125, v1, 4, v125
    v_add_u32 v125, 138240, v125
    s_cmp_eq_u32 s32, 4
    s_cbranch_scc1 AI_w4
    s_barrier
    s_barrier
    s_barrier
    s_barrier
    s_barrier
    s_barrier
    s_barrier
    s_barrier
    s_waitcnt vmcnt(0)
    s_barrier
    s_lshr_b32 s33, s64, 2
    s_and_b32 s34, s64, 3
    s_lshr_b32 s35, s33, 3
    s_lshl_b32 s36, s35, 1
    v_add_u32 v1, s36, v0
    v_and_b32 v1, 15, v1
    v_mov_b32 v2, 14
    v_lshl_add_u32 v4, v1, 4, v2
    v_lshlrev_b32 v4, 7, v4
    v_add_u32 v4, 19922944, v4
    s_mul_i32 s35, s35, 24576
    s_sub_u32 s43, s32, 5
    s_lshl_b32 s43, s43, 13
    s_add_u32 s44, s43, s35
    s_mov_b64 exec, 3
    buffer_load_dword v2, v4, s[12:15], 0 offen sc1
    s_waitcnt vmcnt(0)
    v_cmp_gt_u32 vcc, 1, v2
    s_nop 0
    s_cmp_eq_u64 vcc, 0
    s_cbranch_scc0 K_latei
    s_mov_b64 exec, -1
    s_add_u32 m0, s43, 135168
    s_add_u32 s36, s44, 10485760
    buffer_load_dwordx4 v136, s[12:15], s36 offen offset:0 sc1 lds
    buffer_load_dwordx4 v136, s[12:15], s36 offen offset:1024 sc1 lds
    buffer_load_dwordx4 v136, s[12:15], s36 offen offset:2048 sc1 lds
    buffer_load_dwordx4 v136, s[12:15], s36 offen offset:3072 sc1 lds
    s_add_u32 m0, s43, 139264
    s_add_u32 s36, s44, 10489856
    buffer_load_dwordx4 v136, s[12:15], s36 offen offset:0 sc1 lds
    buffer_load_dwordx4 v136, s[12:15], s36 offen offset:1024 sc1 lds
    buffer_load_dwordx4 v136, s[12:15], s36 offen offset:2048 sc1 lds
    buffer_load_dwordx4 v136, s[12:15], s36 offen offset:3072 sc1 lds
    s_barrier
    s_branch K_donei
K_latei:
    s_barrier
    s_mov_b32 s42, 20000
K_polli:
    buffer_load_dword v2, v4, s[12:15], 0 offen sc1
    s_waitcnt vmcnt(0)
    v_cmp_gt_u32 vcc, 1, v2
    s_nop 0
    s_cmp_eq_u64 vcc, 0
    s_cbranch_scc1 K_polli_ok
    s_sleep 3
    s_sub_u32 s42, s42, 1
    s_cmp_lg_u32 s42, 0
    s_cbranch_scc1 K_polli
K_polli_ok:
    s_mov_b64 exec, -1
    s_add_u32 m0, s43, 135168
    s_add_u32 s36, s44, 10485760
    buffer_load_dwordx4 v136, s[12:15], s36 offen offset:0 sc1 lds
    buffer_load_dwordx4 v136, s[12:15], s36 offen offset:1024 sc1 lds
    buffer_load_dwordx4 v136, s[12:15], s36 offen offset:2048 sc1 lds
    buffer_load_dwordx4 v136, s[12:15], s36 offen offset:3072 sc1 lds
    s_add_u32 m0, s43, 139264
    s_add_u32 s36, s44, 10489856
    buffer_load_dwordx4 v136, s[12:15], s36 offen offset:0 sc1 lds
    buffer_load_dwordx4 v136, s[12:15], s36 offen offset:1024 sc1 lds
    buffer_load_dwordx4 v136, s[12:15], s36 offen offset:2048 sc1 lds
    buffer_load_dwordx4 v136, s[12:15], s36 offen offset:3072 sc1 lds
K_donei:
    s_waitcnt vmcnt(0)
    s_mov_b64 exec, 1
    v_mov_b32 v2, 162832
    v_mov_b32 v3, 1
    ds_add_u32 v2, v3
    s_mov_b64 exec, -1
    s_mov_b32 exec_lo, 63
    s_mov_b32 exec_hi, 0
    s_mov_b32 s42, 20000
K_morei:
    buffer_load_dword v2, v4, s[12:15], 0 offen sc1
    s_waitcnt vmcnt(0)
    v_cmp_gt_u32 vcc, 1, v2
    s_nop 0
    s_cmp_eq_u64 vcc, 0
    s_cbranch_scc1 K_morei_ok
    s_sleep 3
    s_sub_u32 s42, s42, 1
    s_cmp_lg_u32 s42, 0
    s_cbranch_scc1 K_morei
K_morei_ok:
    s_mov_b64 exec, -1
    s_lshr_b32 s35, s33, 3
    s_add_u32 s35, s35, 1
    s_and_b32 s35, s35, 7
    s_mul_i32 s35, s35, 24576
    s_add_u32 s44, s43, s35
    s_add_u32 m0, s43, 110592
    s_add_u32 s36, s44, 10485760
    buffer_load_dwordx4 v136, s[12:15], s36 offen offset:0 sc1 lds
    buffer_load_dwordx4 v136, s[12:15], s36 offen offset:1024 sc1 lds
    buffer_load_dwordx4 v136, s[12:15], s36 offen offset:2048 sc1 lds
    buffer_load_dwordx4 v136, s[12:15], s36 offen offset:3072 sc1 lds
    s_add_u32 m0, s43, 114688
    s_add_u32 s36, s44, 10489856
    buffer_load_dwordx4 v136, s[12:15], s36 offen offset:0 sc1 lds
    buffer_load_dwordx4 v136, s[12:15], s36 offen offset:1024 sc1 lds
    buffer_load_dwordx4 v136, s[12:15], s36 offen offset:2048 sc1 lds
    buffer_load_dwordx4 v136, s[12:15], s36 offen offset:3072 sc1 lds
    s_mov_b64 exec, -1
    s_lshr_b32 s35, s33, 3
    s_add_u32 s35, s35, 2
    s_and_b32 s35, s35, 7
    s_mul_i32 s35, s35, 24576
    s_add_u32 s44, s43, s35
    s_add_u32 m0, s43, 86016
    s_add_u32 s36, s44, 10485760
    buffer_load_dwordx4 v136, s[12:15], s36 offen offset:0 sc1 lds
    buffer_load_dwordx4 v136, s[12:15], s36 offen offset:1024 sc1 lds
    buffer_load_dwordx4 v136, s[12:15], s36 offen offset:2048 sc1 lds
    buffer_load_dwordx4 v136, s[12:15], s36 offen offset:3072 sc1 lds
    s_add_u32 m0, s43, 90112
    s_add_u32 s36, s44, 10489856
    buffer_load_dwordx4 v136, s[12:15], s36 offen offset:0 sc1 lds
    buffer_load_dwordx4 v136, s[12:15], s36 offen offset:1024 sc1 lds
    buffer_load_dwordx4 v136, s[12:15], s36 offen offset:2048 sc1 lds
    buffer_load_dwordx4 v136, s[12:15], s36 offen offset:3072 sc1 lds
    s_branch F_attn
AI_w4:
    s_setprio 3
    s_barrier
    s_barrier
    s_barrier
    s_barrier
    s_barrier
    s_mov_b32 s16, s62
    s_and_b32 s17, s63, 0xffff
    s_mov_b32 s18, 256
    s_mov_b32 s19, 0x20000
    v_lshlrev_b32 v1, 2, v0
    s_mov_b32 exec_lo, 0xffff
    s_mov_b32 exec_hi, 0
    s_mov_b32 s42, 20000
    buffer_load_dword v2, v1, s[16:19], 0 offen sc1
    s_barrier
    s_branch AI_dbg_chk
AI_dbg:
    buffer_load_dword v2, v1, s[16:19], 0 offen sc1
AI_dbg_chk:
    s_waitcnt vmcnt(0)
    v_cmp_ne_u32 vcc, 1, v2
    s_nop 0
    s_cmp_eq_u64 vcc, 0
    s_cbranch_scc1 AI_dbg_ok
    s_sleep 8
    s_sub_u32 s42, s42, 1
    s_cmp_lg_u32 s42, 0
    s_cbranch_scc1 AI_dbg
AI_dbg_ok:
    s_mov_b64 exec, -1
    s_barrier
    s_barrier
    s_lshl_b32 s45, s33, 10
    s_add_u32 s45, s45, 20054016
    v_lshlrev_b32 v1, 3, v0
    s_mov_b32 s42, 20000
    buffer_load_dwordx2 v[4:5], v1, s[12:15], s45 offen sc1
    buffer_load_dwordx2 v[6:7], v1, s[12:15], s45 offen offset:512 sc1
    s_barrier
    s_branch AI_stat_chk
AI_stat:
    buffer_load_dwordx2 v[4:5], v1, s[12:15], s45 offen sc1
    buffer_load_dwordx2 v[6:7], v1, s[12:15], s45 offen offset:512 sc1
AI_stat_chk:
    s_waitcnt vmcnt(0)
    v_min_u32 v2, v5, v7
    v_cmp_eq_u32 vcc, 0, v2
    s_nop 0
    s_cmp_eq_u64 vcc, 0
    s_cbranch_scc1 AI_stat_ok
    s_sleep 2
    s_sub_u32 s42, s42, 1
    s_cmp_lg_u32 s42, 0
    s_cbranch_scc1 AI_stat
AI_stat_ok:
    v_lshlrev_b32 v1, 2, v0
    v_add_u32 v1, 159744, v1
    v_mul_f32 v5, s44, v5
    v_mul_f32 v7, s44, v7
    ds_write_b32 v1, v4
    ds_write_b32 v1, v6 offset:256
    ds_write_b32 v1, v5 offset:512
    ds_write_b32 v1, v7 offset:768
    s_waitcnt lgkmcnt(0)
    s_barrier
    s_setprio 0
    s_branch F_attn
A_spare:
    s_waitcnt lgkmcnt(0)
    s_mov_b32 s4, s20
    s_and_b32 s5, s21, 0xffff
    s_mov_b32 s6, 2621440
    s_mov_b32 s7, 0x20000
    s_mov_b32 s12, s30
    s_and_b32 s13, s31, 0xffff
    s_mov_b32 s14, 31457280
    s_mov_b32 s15, 0x20000
    s_cmp_lg_u32 s32, 8
    s_cbranch_scc1 A_noclear
    v_mov_b32 v4, 0
    v_mov_b32 v5, 0
    v_mov_b32 v6, 0
    v_mov_b32 v7, 0
    v_lshlrev_b32 v1, 4, v0
    s_lshl_b32 s45, s33, 10
    s_add_u32 s45, s45, 20054016
    buffer_store_dwordx4 v[4:7], v1, s[12:15], s45 offen sc1
    v_lshlrev_b32 v1, 7, v0
    s_lshl_b32 s45, s33, 12
    s_add_u32 s45, s45, 19922944
    s_mov_b32 exec_hi, 0
    buffer_store_dwordx4 v[4:7], v1, s[12:15], s45 offen sc1
    s_barrier
    s_mov_b32 s16, s62
    s_and_b32 s17, s63, 0xffff
    s_mov_b32 s18, 256
    s_mov_b32 s19, 0x20000
    v_mov_b32 v3, 1
    s_lshl_b32 s45, s33, 2
    s_waitcnt vmcnt(0)
    s_mov_b64 exec, 1
    buffer_store_dword v3, v4, s[16:19], s45 offen sc1
    s_mov_b64 exec, -1
    s_branch A_cleared
A_noclear:
    s_mov_b32 s54, 0x61508394
    s_movk_i32 s55, 0x72
    s_barrier
A_cleared:
    s_cmp_ge_u32 s32, 8
    s_cbranch_scc1 AP_clear
    v_lshrrev_b32 v1, 3, v0
    s_lshl_b32 s45, s32, 4
    v_add_u32 v1, s45, v1
    v_mul_u32_u24 v1, 1280, v1
    v_and_b32 v2, 7, v0
    v_lshl_add_u32 v1, v2, 4, v1
    s_add_u32 s45, s51, 10240
    s_and_b32 s50, s54, 15
    s_lshr_b64 s[54:55], s[54:55], 4
    s_lshl_b32 s50, s50, 7
    s_add_u32 s37, s50, s51
    s_add_u32 s38, s50, s45
    buffer_load_dwordx4 v[16:19], v1, s[4:7], s37 offen
    buffer_load_dwordx4 v[20:23], v1, s[4:7], s38 offen
    s_and_b32 s50, s54, 15
    s_lshr_b64 s[54:55], s[54:55], 4
    s_lshl_b32 s50, s50, 7
    s_add_u32 s37, s50, s51
    s_add_u32 s38, s50, s45
    buffer_load_dwordx4 v[24:27], v1, s[4:7], s37 offen
    buffer_load_dwordx4 v[28:31], v1, s[4:7], s38 offen
    s_and_b32 s50, s54, 15
    s_lshr_b64 s[54:55], s[54:55], 4
    s_lshl_b32 s50, s50, 7
    s_add_u32 s37, s50, s51
    s_add_u32 s38, s50, s45
    buffer_load_dwordx4 v[32:35], v1, s[4:7], s37 offen
    buffer_load_dwordx4 v[36:39], v1, s[4:7], s38 offen
    s_mov_b32 s43, 0x3f803f80
    v_mov_b32 v8, 0
    v_mov_b32 v9, 0
    v_mov_b32 v10, 0
    v_mov_b32 v11, 0
    v_mov_b32 v12, 0
    v_mov_b32 v13, 0
    v_mov_b32 v14, 0
    v_mov_b32 v15, 0
    s_waitcnt vmcnt(4)
    s_and_b32 s50, s54, 15
    s_lshr_b64 s[54:55], s[54:55], 4
    s_lshl_b32 s50, s50, 7
    s_add_u32 s37, s50, s51
    s_add_u32 s38, s50, s45
    buffer_load_dwordx4 v[40:43], v1, s[4:7], s37 offen
    buffer_load_dwordx4 v[44:47], v1, s[4:7], s38 offen
    v_dot2c_f32_bf16 v8, s43, v16
    v_dot2c_f32_bf16 v12, v16, v16
    v_dot2c_f32_bf16 v9, s43, v17
    v_dot2c_f32_bf16 v13, v17, v17
    v_dot2c_f32_bf16 v8, s43, v18
    v_dot2c_f32_bf16 v12, v18, v18
    v_dot2c_f32_bf16 v9, s43, v19
    v_dot2c_f32_bf16 v13, v19, v19
    v_dot2c_f32_bf16 v10, s43, v20
    v_dot2c_f32_bf16 v14, v20, v20
    v_dot2c_f32_bf16 v11, s43, v21
    v_dot2c_f32_bf16 v15, v21, v21
    v_dot2c_f32_bf16 v10, s43, v22
    v_dot2c_f32_bf16 v14, v22, v22
    v_dot2c_f32_bf16 v11, s43, v23
    v_dot2c_f32_bf16 v15, v23, v23
    s_waitcnt vmcnt(4)
    s_and_b32 s50, s54, 15
    s_lshr_b64 s[54:55], s[54:55], 4
    s_lshl_b32 s50, s50, 7
    s_add_u32 s37, s50, s51
    s_add_u32 s38, s50, s45
    buffer_load_dwordx4 v[48:51], v1, s[4:7], s37 offen
    buffer_load_dwordx4 v[52:55], v1, s[4:7], s38 offen
    v_dot2c_f32_bf16 v8, s43, v24
    v_dot2c_f32_bf16 v12, v24, v24
    v_dot2c_f32_bf16 v9, s43, v25
    v_dot2c_f32_bf16 v13, v25, v25
    v_dot2c_f32_bf16 v8, s43, v26
    v_dot2c_f32_bf16 v12, v26, v26
    v_dot2c_f32_bf16 v9, s43, v27
    v_dot2c_f32_bf16 v13, v27, v27
    v_dot2c_f32_bf16 v10, s43, v28
    v_dot2c_f32_bf16 v14, v28, v28
    v_dot2c_f32_bf16 v11, s43, v29
    v_dot2c_f32_bf16 v15, v29, v29
    v_dot2c_f32_bf16 v10, s43, v30
    v_dot2c_f32_bf16 v14, v30, v30
    v_dot2c_f32_bf16 v11, s43, v31
    v_dot2c_f32_bf16 v15, v31, v31
    s_waitcnt vmcnt(4)
    s_and_b32 s50, s54, 15
    s_lshr_b64 s[54:55], s[54:55], 4
    s_lshl_b32 s50, s50, 7
    s_add_u32 s37, s50, s51
    s_add_u32 s38, s50, s45
    buffer_load_dwordx4 v[56:59], v1, s[4:7], s37 offen
    buffer_load_dwordx4 v[60:63], v1, s[4:7], s38 offen
    v_dot2c_f32_bf16 v8, s43, v32
    v_dot2c_f32_bf16 v12, v32, v32
    v_dot2c_f32_bf16 v9, s43, v33
    v_dot2c_f32_bf16 v13, v33, v33
    v_dot2c_f32_bf16 v8, s43, v34
    v_dot2c_f32_bf16 v12, v34, v34
    v_dot2c_f32_bf16 v9, s43, v35
    v_dot2c_f32_bf16 v13, v35, v35
    v_dot2c_f32_bf16 v10, s43, v36
    v_dot2c_f32_bf16 v14, v36, v36
    v_dot2c_f32_bf16 v11, s43, v37
    v_dot2c_f32_bf16 v15, v37, v37
    v_dot2c_f32_bf16 v10, s43, v38
    v_dot2c_f32_bf16 v14, v38, v38
    v_dot2c_f32_bf16 v11, s43, v39
    v_dot2c_f32_bf16 v15, v39, v39
    s_waitcnt vmcnt(4)
    s_and_b32 s50, s54, 15
    s_lshr_b64 s[54:55], s[54:55], 4
    s_lshl_b32 s50, s50, 7
    s_add_u32 s37, s50, s51
    s_add_u32 s38, s50, s45
    buffer_load_dwordx4 v[64:67], v1, s[4:7], s37 offen
    buffer_load_dwordx4 v[68:71], v1, s[4:7], s38 offen
    v_dot2c_f32_bf16 v8, s43, v40
    v_dot2c_f32_bf16 v12, v40, v40
    v_dot2c_f32_bf16 v9, s43, v41
    v_dot2c_f32_bf16 v13, v41, v41
    v_dot2c_f32_bf16 v8, s43, v42
    v_dot2c_f32_bf16 v12, v42, v42
    v_dot2c_f32_bf16 v9, s43, v43
    v_dot2c_f32_bf16 v13, v43, v43
    v_dot2c_f32_bf16 v10, s43, v44
    v_dot2c_f32_bf16 v14, v44, v44
    v_dot2c_f32_bf16 v11, s43, v45
    v_dot2c_f32_bf16 v15, v45, v45
    v_dot2c_f32_bf16 v10, s43, v46
    v_dot2c_f32_bf16 v14, v46, v46
    v_dot2c_f32_bf16 v11, s43, v47
    v_dot2c_f32_bf16 v15, v47, v47
    s_waitcnt vmcnt(4)
    s_and_b32 s50, s54, 15
    s_lshr_b64 s[54:55], s[54:55], 4
    s_lshl_b32 s50, s50, 7
    s_add_u32 s37, s50, s51
    s_add_u32 s38, s50, s45
    buffer_load_dwordx4 v[72:75], v1, s[4:7], s37 offen
    buffer_load_dwordx4 v[76:79], v1, s[4:7], s38 offen
    v_dot2c_f32_bf16 v8, s43, v48
    v_dot2c_f32_bf16 v12, v48, v48
    v_dot2c_f32_bf16 v9, s43, v49
    v_dot2c_f32_bf16 v13, v49, v49
    v_dot2c_f32_bf16 v8, s43, v50
    v_dot2c_f32_bf16 v12, v50, v50
    v_dot2c_f32_bf16 v9, s43, v51
    v_dot2c_f32_bf16 v13, v51, v51
    v_dot2c_f32_bf16 v10, s43, v52
    v_dot2c_f32_bf16 v14, v52, v52
    v_dot2c_f32_bf16 v11, s43, v53
    v_dot2c_f32_bf16 v15, v53, v53
    v_dot2c_f32_bf16 v10, s43, v54
    v_dot2c_f32_bf16 v14, v54, v54
    v_dot2c_f32_bf16 v11, s43, v55
    v_dot2c_f32_bf16 v15, v55, v55
    s_waitcnt vmcnt(4)
    s_and_b32 s50, s54, 15
    s_lshr_b64 s[54:55], s[54:55], 4
    s_lshl_b32 s50, s50, 7
    s_add_u32 s37, s50, s51
    s_add_u32 s38, s50, s45
    buffer_load_dwordx4 v[80:83], v1, s[4:7], s37 offen
    buffer_load_dwordx4 v[84:87], v1, s[4:7], s38 offen
    v_dot2c_f32_bf16 v8, s43, v56
    v_dot2c_f32_bf16 v12, v56, v56
    v_dot2c_f32_bf16 v9, s43, v57
    v_dot2c_f32_bf16 v13, v57, v57
    v_dot2c_f32_bf16 v8, s43, v58
    v_dot2c_f32_bf16 v12, v58, v58
    v_dot2c_f32_bf16 v9, s43, v59
    v_dot2c_f32_bf16 v13, v59, v59
    v_dot2c_f32_bf16 v10, s43, v60
    v_dot2c_f32_bf16 v14, v60, v60
    v_dot2c_f32_bf16 v11, s43, v61
    v_dot2c_f32_bf16 v15, v61, v61
    v_dot2c_f32_bf16 v10, s43, v62
    v_dot2c_f32_bf16 v14, v62, v62
    v_dot2c_f32_bf16 v11, s43, v63
    v_dot2c_f32_bf16 v15, v63, v63
    s_waitcnt vmcnt(4)
    s_and_b32 s50, s54, 15
    s_lshr_b64 s[54:55], s[54:55], 4
    s_lshl_b32 s50, s50, 7
    s_add_u32 s37, s50, s51
    s_add_u32 s38, s50, s45
    buffer_load_dwordx4 v[88:91], v1, s[4:7], s37 offen
    buffer_load_dwordx4 v[92:95], v1, s[4:7], s38 offen
    v_dot2c_f32_bf16 v8, s43, v64
    v_dot2c_f32_bf16 v12, v64, v64
    v_dot2c_f32_bf16 v9, s43, v65
    v_dot2c_f32_bf16 v13, v65, v65
    v_dot2c_f32_bf16 v8, s43, v66
    v_dot2c_f32_bf16 v12, v66, v66
    v_dot2c_f32_bf16 v9, s43, v67
    v_dot2c_f32_bf16 v13, v67, v67
    v_dot2c_f32_bf16 v10, s43, v68
    v_dot2c_f32_bf16 v14, v68, v68
    v_dot2c_f32_bf16 v11, s43, v69
    v_dot2c_f32_bf16 v15, v69, v69
    v_dot2c_f32_bf16 v10, s43, v70
    v_dot2c_f32_bf16 v14, v70, v70
    v_dot2c_f32_bf16 v11, s43, v71
    v_dot2c_f32_bf16 v15, v71, v71
    s_waitcnt vmcnt(4)
    v_dot2c_f32_bf16 v8, s43, v72
    v_dot2c_f32_bf16 v12, v72, v72
    v_dot2c_f32_bf16 v9, s43, v73
    v_dot2c_f32_bf16 v13, v73, v73
    v_dot2c_f32_bf16 v8, s43, v74
    v_dot2c_f32_bf16 v12, v74, v74
    v_dot2c_f32_bf16 v9, s43, v75
    v_dot2c_f32_bf16 v13, v75, v75
    v_dot2c_f32_bf16 v10, s43, v76
    v_dot2c_f32_bf16 v14, v76, v76
    v_dot2c_f32_bf16 v11, s43, v77
    v_dot2c_f32_bf16 v15, v77, v77
    v_dot2c_f32_bf16 v10, s43, v78
    v_dot2c_f32_bf16 v14, v78, v78
    v_dot2c_f32_bf16 v11, s43, v79
    v_dot2c_f32_bf16 v15, v79, v79
    s_waitcnt vmcnt(2)
    v_dot2c_f32_bf16 v8, s43, v80
    v_dot2c_f32_bf16 v12, v80, v80
    v_dot2c_f32_bf16 v9, s43, v81
    v_dot2c_f32_bf16 v13, v81, v81
    v_dot2c_f32_bf16 v8, s43, v82
    v_dot2c_f32_bf16 v12, v82, v82
    v_dot2c_f32_bf16 v9, s43, v83
    v_dot2c_f32_bf16 v13, v83, v83
    v_dot2c_f32_bf16 v10, s43, v84
    v_dot2c_f32_bf16 v14, v84, v84
    v_dot2c_f32_bf16 v11, s43, v85
    v_dot2c_f32_bf16 v15, v85, v85
    v_dot2c_f32_bf16 v10, s43, v86
    v_dot2c_f32_bf16 v14, v86, v86
    v_dot2c_f32_bf16 v11, s43, v87
    v_dot2c_f32_bf16 v15, v87, v87
    s_waitcnt vmcnt(0)
    v_dot2c_f32_bf16 v8, s43, v88
    v_dot2c_f32_bf16 v12, v88, v88
    v_dot2c_f32_bf16 v9, s43, v89
    v_dot2c_f32_bf16 v13, v89, v89
    v_dot2c_f32_bf16 v8, s43, v90
    v_dot2c_f32_bf16 v12, v90, v90
    v_dot2c_f32_bf16 v9, s43, v91
    v_dot2c_f32_bf16 v13, v91, v91
    v_dot2c_f32_bf16 v10, s43, v92
    v_dot2c_f32_bf16 v14, v92, v92
    v_dot2c_f32_bf16 v11, s43, v93
    v_dot2c_f32_bf16 v15, v93, v93
    v_dot2c_f32_bf16 v10, s43, v94
    v_dot2c_f32_bf16 v14, v94, v94
    v_dot2c_f32_bf16 v11, s43, v95
    v_dot2c_f32_bf16 v15, v95, v95
    v_add_f32 v8, v8, v9
    s_nop 0
    v_add_f32 v10, v10, v11
    v_add_f32 v12, v12, v13
    v_add_f32 v14, v14, v15
    v_add_f32_dpp v8, v8, v8 quad_perm:[1,0,3,2] row_mask:0xf bank_mask:0xf
    v_add_f32_dpp v10, v10, v10 quad_perm:[1,0,3,2] row_mask:0xf bank_mask:0xf
    v_add_f32_dpp v12, v12, v12 quad_perm:[1,0,3,2] row_mask:0xf bank_mask:0xf
    v_add_f32_dpp v14, v14, v14 quad_perm:[1,0,3,2] row_mask:0xf bank_mask:0xf
    v_add_f32_dpp v8, v8, v8 quad_perm:[2,3,0,1] row_mask:0xf bank_mask:0xf
    v_add_f32_dpp v10, v10, v10 quad_perm:[2,3,0,1] row_mask:0xf bank_mask:0xf
    v_add_f32_dpp v12, v12, v12 quad_perm:[2,3,0,1] row_mask:0xf bank_mask:0xf
    v_add_f32_dpp v14, v14, v14 quad_perm:[2,3,0,1] row_mask:0xf bank_mask:0xf
    v_add_f32_dpp v8, v8, v8 row_half_mirror row_mask:0xf bank_mask:0xf
    v_add_f32_dpp v10, v10, v10 row_half_mirror row_mask:0xf bank_mask:0xf
    v_add_f32_dpp v12, v12, v12 row_half_mirror row_mask:0xf bank_mask:0xf
    v_add_f32_dpp v14, v14, v14 row_half_mirror row_mask:0xf bank_mask:0xf
    v_and_b32 v2, 1, v0
    v_cmp_eq_u32 vcc, 1, v2
    s_nop 1
    v_cndmask_b32 v4, v8, v10, vcc
    v_cndmask_b32 v5, v12, v14, vcc
    v_mul_f32 v4, 0x3acccccd, v4
    v_mul_f32 v5, 0x3acccccd, v5
    v_fma_f32 v5, -v4, v4, v5
    v_max_f32 v5, 0, v5
    v_cvt_pk_bf16_f32 v5, v5, v5
    v_lshlrev_b32 v5, 16, v5
    v_add_f32 v5, 0x3727c5ac, v5
    v_cvt_pk_bf16_f32 v5, v5, v5
    v_lshlrev_b32 v5, 16, v5
    v_sqrt_f32 v5, v5
    s_nop 0
    v_cvt_pk_bf16_f32 v5, v5, v5
    v_lshlrev_b32 v5, 16, v5
    v_rcp_f32 v5, v5
    v_cvt_pk_bf16_f32 v4, -v4, -v4
    v_lshrrev_b32 v1, 3, v0
    v_lshl_add_u32 v1, v2, 3, v1
    v_lshlrev_b32 v1, 3, v1
    v_or_b32 v5, 1, v5
    s_lshl_b32 s45, s33, 10
    s_lshl_b32 s46, s32, 7
    s_add_u32 s45, s45, s46
    s_add_u32 s45, s45, 20054016
    s_barrier
    s_mov_b32 exec_lo, 0x03030303
    s_mov_b32 exec_hi, 0x03030303
    buffer_store_dwordx2 v[4:5], v1, s[12:15], s45 offen sc1
    s_mov_b64 exec, -1
    s_branch AP_done
AP_clear:
AP_bar:
    s_barrier
AP_done:
    v_lshlrev_b32 v1, 2, v0
    v_add_u32 v1, 162816, v1
    v_mov_b32 v2, 0
    ds_write_b32 v1, v2
    ds_write_b32 v1, v2 offset:256
    v_cmp_lt_u32 vcc, 6, v0
    s_nop 1
    v_cndmask_b32 v2, 0, 4, vcc
    ds_write_b32 v1, v2 offset:512
    s_waitcnt lgkmcnt(0)
    s_and_b32 s64, s2, 1
    s_lshl_b32 s64, s64, 3
    s_lshr_b32 s35, s2, 5
    s_add_u32 s64, s64, s35
    s_lshl_b32 s64, s64, 2
    s_bfe_u32 s35, s2, 0x20001
    s_add_u32 s64, s64, s35
    s_lshl_b32 s64, s64, 2
    s_bfe_u32 s35, s2, 0x20003
    s_add_u32 s64, s64, s35
    s_and_b32 s35, s64, 3
    s_lshl_b32 s35, s35, 3
    s_add_u32 s35, s35, s32
    s_mul_i32 s35, s35, 5
    v_lshrrev_b32 v2, 5, v0
    v_and_b32 v3, 31, v0
    v_lshlrev_b32 v3, 4, v3
    v_add_u32 v1, s35, v2
    v_lshrrev_b32 v130, 2, v1
    v_lshl_add_u32 v126, v130, 10, v3
    v_and_b32 v130, 1, v1
    v_lshl_add_u32 v126, v130, 9, v126
    v_bfe_u32 v130, v1, 1, 1
    v_lshl_add_u32 v126, v130, 3, v126
    v_add_u32 v1, s35, v2
    v_add_u32 v1, 2, v1
    v_lshrrev_b32 v130, 2, v1
    v_lshl_add_u32 v127, v130, 10, v3
    v_and_b32 v130, 1, v1
    v_lshl_add_u32 v127, v130, 9, v127
    v_bfe_u32 v130, v1, 1, 1
    v_lshl_add_u32 v127, v130, 3, v127
    v_mov_b32 v1, s35
    v_add_u32 v1, 4, v1
    v_lshrrev_b32 v130, 2, v1
    v_lshl_add_u32 v128, v130, 10, v3
    v_and_b32 v130, 1, v1
    v_lshl_add_u32 v128, v130, 9, v128
    v_bfe_u32 v130, v1, 1, 1
    v_lshl_add_u32 v128, v130, 3, v128
    v_lshlrev_b32 v136, 4, v0
    v_add_u32 v124, 135168, v136
    v_lshlrev_b32 v137, 2, v0
    v_add_u32 v137, 163072, v137
    v_cmp_eq_u32 vcc, 0, v0
    s_nop 1
    v_cndmask_b32 v138, 0, 1, vcc
    v_and_b32 v1, 31, v0
    v_min_u32 v1, 23, v1
    v_mul_u32_u24 v125, 384, v2
    v_lshl_add_u32 v125, v1, 4, v125
    v_add_u32 v125, 138240, v125
    s_cmp_lg_u32 s32, 0
    s_cbranch_scc1 F_sp1
    s_mov_b32 s16, s62
    s_and_b32 s17, s63, 0xffff
    s_mov_b32 s18, 256
    s_mov_b32 s19, 0x20000
    v_lshlrev_b32 v1, 2, v0
    s_mov_b32 exec_lo, 0xffff
    s_mov_b32 exec_hi, 0
    s_mov_b32 s42, 20000
F_dbg:
    buffer_load_dword v2, v1, s[16:19], 0 offen sc1
    s_waitcnt vmcnt(0)
    v_cmp_ne_u32 vcc, 1, v2
    s_nop 0
    s_cmp_eq_u64 vcc, 0
    s_cbranch_scc1 F_dbg_ok
    s_sleep 8
    s_sub_u32 s42, s42, 1
    s_cmp_lg_u32 s42, 0
    s_cbranch_scc1 F_dbg
F_dbg_ok:
    s_mov_b64 exec, -1
F_sp1:
    s_barrier
    s_cmp_ge_u32 s32, 8
    s_cbranch_scc1 F_gemm0
    s_lshr_b32 s33, s64, 2
    s_and_b32 s34, s64, 3
    s_lshr_b32 s35, s33, 2
    v_mov_b32 v1, s35
    s_add_u32 s36, s34, 9
    v_add_u32 v2, s36, v0
    v_lshl_add_u32 v4, v1, 4, v2
    v_lshlrev_b32 v4, 7, v4
    v_add_u32 v4, 19922944, v4
    s_mov_b64 exec, 3
    v_mov_b32 v6, 0
    s_mov_b64 exec, -1
    s_cmp_lt_u32 s32, 5
    s_cbranch_scc1 F_fetch
    s_lshr_b32 s33, s64, 2
    s_and_b32 s34, s64, 3
    s_lshr_b32 s35, s33, 3
    s_lshl_b32 s36, s35, 1
    v_add_u32 v1, s36, v0
    v_and_b32 v1, 15, v1
    v_mov_b32 v2, 14
    v_lshl_add_u32 v4, v1, 4, v2
    v_lshlrev_b32 v4, 7, v4
    v_add_u32 v4, 19922944, v4
    s_mul_i32 s35, s35, 24576
    s_sub_u32 s43, s32, 5
    s_lshl_b32 s43, s43, 13
    s_add_u32 s44, s43, s35
    s_mov_b64 exec, 3
    s_mov_b32 s42, 20000
K_polls:
    buffer_load_dword v2, v4, s[12:15], 0 offen sc1
    s_waitcnt vmcnt(0)
    v_cmp_gt_u32 vcc, 1, v2
    s_nop 0
    s_cmp_eq_u64 vcc, 0
    s_cbranch_scc1 K_polls_ok
    s_sleep 3
    s_sub_u32 s42, s42, 1
    s_cmp_lg_u32 s42, 0
    s_cbranch_scc1 K_polls
K_polls_ok:
    s_mov_b64 exec, -1
    s_add_u32 m0, s43, 135168
    s_add_u32 s36, s44, 10485760
    buffer_load_dwordx4 v136, s[12:15], s36 offen offset:0 sc1 lds
    buffer_load_dwordx4 v136, s[12:15], s36 offen offset:1024 sc1 lds
    buffer_load_dwordx4 v136, s[12:15], s36 offen offset:2048 sc1 lds
    buffer_load_dwordx4 v136, s[12:15], s36 offen offset:3072 sc1 lds
    s_add_u32 m0, s43, 139264
    s_add_u32 s36, s44, 10489856
    buffer_load_dwordx4 v136, s[12:15], s36 offen offset:0 sc1 lds
    buffer_load_dwordx4 v136, s[12:15], s36 offen offset:1024 sc1 lds
    buffer_load_dwordx4 v136, s[12:15], s36 offen offset:2048 sc1 lds
    buffer_load_dwordx4 v136, s[12:15], s36 offen offset:3072 sc1 lds
K_dones:
    s_waitcnt vmcnt(0)
    s_mov_b64 exec, 1
    v_mov_b32 v2, 162832
    v_mov_b32 v3, 1
    ds_add_u32 v2, v3
    s_mov_b64 exec, -1
    s_mov_b32 exec_lo, 63
    s_mov_b32 exec_hi, 0
    s_mov_b32 s42, 20000
K_mores:
    buffer_load_dword v2, v4, s[12:15], 0 offen sc1
    s_waitcnt vmcnt(0)
    v_cmp_gt_u32 vcc, 1, v2
    s_nop 0
    s_cmp_eq_u64 vcc, 0
    s_cbranch_scc1 K_mores_ok
    s_sleep 3
    s_sub_u32 s42, s42, 1
    s_cmp_lg_u32 s42, 0
    s_cbranch_scc1 K_mores
K_mores_ok:
    s_mov_b64 exec, -1
    s_lshr_b32 s35, s33, 3
    s_add_u32 s35, s35, 1
    s_and_b32 s35, s35, 7
    s_mul_i32 s35, s35, 24576
    s_add_u32 s44, s43, s35
    s_add_u32 m0, s43, 110592
    s_add_u32 s36, s44, 10485760
    buffer_load_dwordx4 v136, s[12:15], s36 offen offset:0 sc1 lds
    buffer_load_dwordx4 v136, s[12:15], s36 offen offset:1024 sc1 lds
    buffer_load_dwordx4 v136, s[12:15], s36 offen offset:2048 sc1 lds
    buffer_load_dwordx4 v136, s[12:15], s36 offen offset:3072 sc1 lds
    s_add_u32 m0, s43, 114688
    s_add_u32 s36, s44, 10489856
    buffer_load_dwordx4 v136, s[12:15], s36 offen offset:0 sc1 lds
    buffer_load_dwordx4 v136, s[12:15], s36 offen offset:1024 sc1 lds
    buffer_load_dwordx4 v136, s[12:15], s36 offen offset:2048 sc1 lds
    buffer_load_dwordx4 v136, s[12:15], s36 offen offset:3072 sc1 lds
    s_mov_b64 exec, -1
    s_lshr_b32 s35, s33, 3
    s_add_u32 s35, s35, 2
    s_and_b32 s35, s35, 7
    s_mul_i32 s35, s35, 24576
    s_add_u32 s44, s43, s35
    s_add_u32 m0, s43, 86016
    s_add_u32 s36, s44, 10485760
    buffer_load_dwordx4 v136, s[12:15], s36 offen offset:0 sc1 lds
    buffer_load_dwordx4 v136, s[12:15], s36 offen offset:1024 sc1 lds
    buffer_load_dwordx4 v136, s[12:15], s36 offen offset:2048 sc1 lds
    buffer_load_dwordx4 v136, s[12:15], s36 offen offset:3072 sc1 lds
    s_add_u32 m0, s43, 90112
    s_add_u32 s36, s44, 10489856
    buffer_load_dwordx4 v136, s[12:15], s36 offen offset:0 sc1 lds
    buffer_load_dwordx4 v136, s[12:15], s36 offen offset:1024 sc1 lds
    buffer_load_dwordx4 v136, s[12:15], s36 offen offset:2048 sc1 lds
    buffer_load_dwordx4 v136, s[12:15], s36 offen offset:3072 sc1 lds
    s_branch F_attn
F_fetch:
    s_cmp_lg_u32 s32, 0
    s_cbranch_scc1 F_attn
    s_mov_b64 exec, 3
    s_waitcnt vmcnt(0)
    v_cmp_gt_u32 vcc, 1, v6
    s_nop 0
    s_cmp_eq_u64 vcc, 0
    s_cbranch_scc1 B_pollq_ok
    s_mov_b32 s42, 20000
B_pollq:
    buffer_load_dword v6, v4, s[12:15], 0 offen sc1
    s_waitcnt vmcnt(0)
    v_cmp_gt_u32 vcc, 1, v6
    s_nop 0
    s_cmp_eq_u64 vcc, 0
    s_cbranch_scc1 B_pollq_ok
    s_sleep 2
    s_sub_u32 s42, s42, 1
    s_cmp_lg_u32 s42, 0
    s_cbranch_scc1 B_pollq
B_pollq_ok:
    s_mov_b64 exec, 1
    v_mov_b32 v2, 162832
    v_mov_b32 v3, 1
    ds_add_u32 v2, v3
    s_mov_b64 exec, -1
F_attn:
    s_lshr_b32 s33, s64, 2
    s_and_b32 s34, s64, 3
    s_mul_i32 s41, s33, 151552
    v_mov_b32 v88, 0
    v_mov_b32 v89, 0
    v_mov_b32 v90, 0
    v_mov_b32 v91, 0
    v_mov_b32 v16, 0
    v_mov_b32 v17, 0
    v_mov_b32 v18, 0
    v_mov_b32 v19, 0
    v_mov_b32 v20, 0
    v_mov_b32 v21, 0
    v_mov_b32 v22, 0
    v_mov_b32 v23, 0
    v_mov_b32 v24, 0
    v_mov_b32 v25, 0
    v_mov_b32 v26, 0
    v_mov_b32 v27, 0
    v_mov_b32 v28, 0
    v_mov_b32 v29, 0
    v_mov_b32 v30, 0
    v_mov_b32 v31, 0
    v_mov_b32 v32, 0
    v_mov_b32 v33, 0
    v_mov_b32 v34, 0
    v_mov_b32 v35, 0
    s_mov_b32 s37, 0
    s_mov_b32 s38, 73728
    s_mov_b32 s40, 4294942720
    s_mov_b32 s45, 0
    s_mov_b32 s45, 68
    s_setprio 2
B_nops:
    v_mov_b32 v8, 0
    v_mov_b32 v9, 0
    v_mov_b32 v2, 162832
    s_mov_b32 s42, 800000
B_wait:
    ds_read_b32 v3, v2
    s_waitcnt lgkmcnt(0)
    v_readfirstlane_b32 s35, v3
    s_nop 0
    s_cmp_ge_u32 s35, 4
    s_cbranch_scc1 B_wait_ok
    s_sleep 1
    s_sub_u32 s42, s42, 1
    s_cmp_lg_u32 s42, 0
    s_cbranch_scc1 B_wait
B_wait_ok:
    buffer_load_dwordx2 v[4:5], v126, s[12:15], s41 offen sc1
    buffer_load_dwordx2 v[6:7], v127, s[12:15], s41 offen sc1
    s_mov_b32 exec_hi, 0
    buffer_load_dwordx2 v[8:9], v128, s[12:15], s41 offen sc1
    s_mov_b32 exec_hi, -1
    ds_read_b128 v[68:71], v124 offset:0
    ds_read_b128 v[76:79], v124 offset:2048
    ds_read_b128 v[72:75], v124 offset:1024
    ds_read_b128 v[92:95], v125 offset:0
    ds_read_b128 v[108:111], v125 offset:768
    ds_read_b128 v[96:99], v124 offset:6144
    ds_read_b128 v[104:107], v124 offset:8192
    ds_read_b128 v[112:115], v125 offset:1536
    v_mov_b32 v2, 162824
    s_waitcnt vmcnt(0) lgkmcnt(0)
    s_mov_b64 exec, 1
    ds_add_u32 v2, v138
    s_mov_b64 exec, -1
    v_mfma_f32_32x32x16_bf16 v[52:67], v[68:71], v[4:7], 0
    v_mfma_f32_32x32x8_bf16 v[52:67], v[76:77], v[8:9], v[52:67]
    v_mfma_f32_32x32x16_bf16 v[36:51], v[68:71], v[4:7], 0
    s_nop 10
    v_max3_f32 v130, v52, v53, v54
    v_max3_f32 v131, v55, v56, v57
    v_max3_f32 v132, v58, v59, v60
    v_max3_f32 v133, v61, v62, v63
    v_max3_f32 v130, v130, v64, v65
    v_max3_f32 v131, v131, v66, v67
    v_max3_f32 v130, v130, v132, v133
    v_max_f32 v130, v130, v131
    v_mov_b32 v131, v130
    s_nop 1
    v_permlane32_swap_b32 v130, v131
    v_max_f32 v130, v130, v131
    s_mov_b32 exec_lo, 0
    v_cvt_pk_bf16_f32 v8, -v130, 0
    s_mov_b32 exec_lo, -1
    s_nop 0
    v_mfma_f32_32x32x8_bf16 v[36:51], v[76:77], v[8:9], v[36:51]
    s_waitcnt lgkmcnt(0)
    s_nop 10
.p2align 6
B_loop:
    v_cvt_pk_bf16_f32 v18, v64, v65
    v_exp_f32 v36, v36
    v_exp_f32 v37, v37
    v_cvt_pk_bf16_f32 v19, v66, v67
    v_exp_f32 v38, v38
    v_exp_f32 v39, v39
    v_mfma_f32_32x32x16_bf16 v[52:67], v[72:75], v[4:7], 0
    ds_read_b128 v[116:119], v125 offset:2304
    ds_read_b128 v[100:103], v124 offset:7168
    v_exp_f32 v40, v40
    v_exp_f32 v41, v41
    v_cvt_pk_bf16_f32 v12, v36, v37
    v_cvt_pk_bf16_f32 v13, v38, v39
    v_exp_f32 v42, v42
    v_exp_f32 v43, v43
    v_mfma_f32_32x32x8_bf16 v[52:67], v[78:79], v[8:9], v[52:67]
    v_exp_f32 v44, v44
    v_exp_f32 v45, v45
    v_cvt_pk_bf16_f32 v14, v40, v41
    v_cvt_pk_bf16_f32 v15, v42, v43
    v_exp_f32 v46, v46
    v_exp_f32 v47, v47
    v_mfma_f32_32x32x16_bf16 v[20:35], v[88:91], v[16:19], v[20:35]
    ds_read_b128 v[120:123], v125 offset:6144
    s_bitcmp1_b32 s45, s37
    s_cbranch_scc1 B_prio
B_prioret:
    ds_add_u32 v137, v138 offset:0
    v_exp_f32 v48, v48
    v_exp_f32 v49, v49
    v_cvt_pk_bf16_f32 v16, v44, v45
    v_cvt_pk_bf16_f32 v17, v46, v47
    v_exp_f32 v50, v50
    v_exp_f32 v51, v51
    v_mfma_f32_32x32x16_bf16 v[20:35], v[92:95], v[12:15], v[20:35]
    v_cvt_pk_bf16_f32 v18, v48, v49
    v_exp_f32 v52, v52
    v_exp_f32 v53, v53
    v_cvt_pk_bf16_f32 v19, v50, v51
    v_exp_f32 v54, v54
    v_exp_f32 v55, v55
    s_waitcnt lgkmcnt(0)
    v_mfma_f32_32x32x16_bf16 v[36:51], v[96:99], v[4:7], 0
    ds_read_b128 v[80:83], v125 offset:6912
    ds_read_b128 v[84:87], v125 offset:7680
    v_exp_f32 v56, v56
    v_exp_f32 v57, v57
    v_cvt_pk_bf16_f32 v12, v52, v53
    v_cvt_pk_bf16_f32 v13, v54, v55
    v_exp_f32 v58, v58
    v_exp_f32 v59, v59
    v_mfma_f32_32x32x8_bf16 v[36:51], v[104:105], v[8:9], v[36:51]
    v_exp_f32 v60, v60
    v_exp_f32 v61, v61
    v_cvt_pk_bf16_f32 v14, v56, v57
    v_cvt_pk_bf16_f32 v15, v58, v59
    v_exp_f32 v62, v62
    v_exp_f32 v63, v63
    v_mfma_f32_32x32x16_bf16 v[20:35], v[108:111], v[16:19], v[20:35]
    ds_read_b128 v[68:71], v124 offset:12288
    v_exp_f32 v64, v64
    v_exp_f32 v65, v65
    v_cvt_pk_bf16_f32 v16, v60, v61
    v_cvt_pk_bf16_f32 v17, v62, v63
    v_exp_f32 v66, v66
    v_exp_f32 v67, v67
    v_mfma_f32_32x32x16_bf16 v[20:35], v[112:115], v[12:15], v[20:35]
    ds_read_b128 v[76:79], v124 offset:14336
    v_cvt_pk_bf16_f32 v18, v64, v65
    v_exp_f32 v36, v36
    v_exp_f32 v37, v37
    v_cvt_pk_bf16_f32 v19, v66, v67
    v_exp_f32 v38, v38
    v_exp_f32 v39, v39
    v_mfma_f32_32x32x16_bf16 v[52:67], v[100:103], v[4:7], 0
    ds_read_b128 v[88:91], v125 offset:8448
    ds_read_b128 v[72:75], v124 offset:13312
    s_cmp_eq_u32 s38, 0
    s_cselect_b32 s39, 73728, s40
    v_exp_f32 v40, v40
    v_exp_f32 v41, v41
    v_mov_b32_dpp v138, v138 row_shr:1 row_mask:0xf bank_mask:0xf bound_ctrl:0
    v_cvt_pk_bf16_f32 v12, v36, v37
    v_cvt_pk_bf16_f32 v13, v38, v39
    v_exp_f32 v42, v42
    v_exp_f32 v43, v43
    v_mfma_f32_32x32x8_bf16 v[52:67], v[106:107], v[8:9], v[52:67]
    v_exp_f32 v44, v44
    v_exp_f32 v45, v45
    v_cvt_pk_bf16_f32 v14, v40, v41
    v_cvt_pk_bf16_f32 v15, v42, v43
    v_exp_f32 v46, v46
    v_exp_f32 v47, v47
    v_mfma_f32_32x32x16_bf16 v[20:35], v[116:119], v[16:19], v[20:35]
    ds_read_b128 v[92:95], v125 offset:12288
    v_exp_f32 v48, v48
    v_exp_f32 v49, v49
    v_cvt_pk_bf16_f32 v16, v44, v45
    v_cvt_pk_bf16_f32 v17, v46, v47
    v_exp_f32 v50, v50
    v_exp_f32 v51, v51
    v_mfma_f32_32x32x16_bf16 v[20:35], v[120:123], v[12:15], v[20:35]
    v_cvt_pk_bf16_f32 v18, v48, v49
    v_exp_f32 v52, v52
    v_exp_f32 v53, v53
    v_cvt_pk_bf16_f32 v19, v50, v51
    v_exp_f32 v54, v54
    v_exp_f32 v55, v55
    s_waitcnt lgkmcnt(0)
    v_mfma_f32_32x32x16_bf16 v[36:51], v[68:71], v[4:7], 0
    ds_read_b128 v[108:111], v125 offset:13056
    ds_read_b128 v[112:115], v125 offset:13824
    v_exp_f32 v56, v56
    v_exp_f32 v57, v57
    v_cvt_pk_bf16_f32 v12, v52, v53
    v_cvt_pk_bf16_f32 v13, v54, v55
    v_exp_f32 v58, v58
    v_exp_f32 v59, v59
    v_mfma_f32_32x32x8_bf16 v[36:51], v[76:77], v[8:9], v[36:51]
    v_exp_f32 v60, v60
    v_exp_f32 v61, v61
    v_cvt_pk_bf16_f32 v14, v56, v57
    v_cvt_pk_bf16_f32 v15, v58, v59
    v_exp_f32 v62, v62
    v_exp_f32 v63, v63
    v_mfma_f32_32x32x16_bf16 v[20:35], v[80:83], v[16:19], v[20:35]
    ds_read_b128 v[96:99], v124 offset:18432
    v_exp_f32 v64, v64
    v_exp_f32 v65, v65
    v_cvt_pk_bf16_f32 v16, v60, v61
    v_cvt_pk_bf16_f32 v17, v62, v63
    v_exp_f32 v66, v66
    v_exp_f32 v67, v67
    v_mfma_f32_32x32x16_bf16 v[20:35], v[84:87], v[12:15], v[20:35]
    ds_read_b128 v[104:107], v124 offset:20480
    v_cvt_pk_bf16_f32 v18, v64, v65
    v_exp_f32 v36, v36
    v_exp_f32 v37, v37
    v_cvt_pk_bf16_f32 v19, v66, v67
    v_exp_f32 v38, v38
    v_exp_f32 v39, v39
    v_mfma_f32_32x32x16_bf16 v[52:67], v[72:75], v[4:7], 0
    ds_read_b128 v[116:119], v125 offset:14592
    ds_read_b128 v[100:103], v124 offset:19456
    v_exp_f32 v40, v40
    v_exp_f32 v41, v41
    v_cvt_pk_bf16_f32 v12, v36, v37
    v_cvt_pk_bf16_f32 v13, v38, v39
    v_exp_f32 v42, v42
    v_exp_f32 v43, v43
    v_mfma_f32_32x32x8_bf16 v[52:67], v[78:79], v[8:9], v[52:67]
    v_exp_f32 v44, v44
    v_exp_f32 v45, v45
    v_cvt_pk_bf16_f32 v14, v40, v41
    v_cvt_pk_bf16_f32 v15, v42, v43
    v_exp_f32 v46, v46
    v_exp_f32 v47, v47
    v_mfma_f32_32x32x16_bf16 v[20:35], v[88:91], v[16:19], v[20:35]
    ds_read_b128 v[120:123], v125 offset:18432
    ds_read_b32 v139, v137 offset:256
    v_exp_f32 v48, v48
    v_exp_f32 v49, v49
    v_cvt_pk_bf16_f32 v16, v44, v45
    v_cvt_pk_bf16_f32 v17, v46, v47
    v_exp_f32 v50, v50
    v_exp_f32 v51, v51
    v_mfma_f32_32x32x16_bf16 v[20:35], v[92:95], v[12:15], v[20:35]
    v_cvt_pk_bf16_f32 v18, v48, v49
    v_exp_f32 v52, v52
    v_exp_f32 v53, v53
    v_cvt_pk_bf16_f32 v19, v50, v51
    v_exp_f32 v54, v54
    v_exp_f32 v55, v55
    s_waitcnt lgkmcnt(0)
    v_mfma_f32_32x32x16_bf16 v[36:51], v[96:99], v[4:7], 0
    ds_read_b128 v[80:83], v125 offset:19200
    ds_read_b128 v[84:87], v125 offset:19968
    v_readlane_b32 s35, v139, s37
    s_add_u32 s38, s38, s39
    s_cmp_lt_u32 s35, 4
    s_cbranch_scc1 B_spin
B_synced:
    v_exp_f32 v56, v56
    v_exp_f32 v57, v57
    v_add_u32 v124, s39, v124
    v_cvt_pk_bf16_f32 v12, v52, v53
    v_cvt_pk_bf16_f32 v13, v54, v55
    v_exp_f32 v58, v58
    v_exp_f32 v59, v59
    v_mfma_f32_32x32x8_bf16 v[36:51], v[104:105], v[8:9], v[36:51]
    v_exp_f32 v60, v60
    v_exp_f32 v61, v61
    v_cvt_pk_bf16_f32 v14, v56, v57
    v_cvt_pk_bf16_f32 v15, v58, v59
    v_exp_f32 v62, v62
    v_exp_f32 v63, v63
    v_mfma_f32_32x32x16_bf16 v[20:35], v[108:111], v[16:19], v[20:35]
    ds_read_b128 v[68:71], v124 offset:0
    v_exp_f32 v64, v64
    v_exp_f32 v65, v65
    v_cvt_pk_bf16_f32 v16, v60, v61
    v_cvt_pk_bf16_f32 v17, v62, v63
    v_exp_f32 v66, v66
    v_exp_f32 v67, v67
    v_mfma_f32_32x32x16_bf16 v[20:35], v[112:115], v[12:15], v[20:35]
    ds_read_b128 v[76:79], v124 offset:2048
    v_cvt_pk_bf16_f32 v18, v64, v65
    v_exp_f32 v36, v36
    v_exp_f32 v37, v37
    v_cvt_pk_bf16_f32 v19, v66, v67
    v_exp_f32 v38, v38
    v_exp_f32 v39, v39
    v_mfma_f32_32x32x16_bf16 v[52:67], v[100:103], v[4:7], 0
    ds_read_b128 v[88:91], v125 offset:20736
    ds_read_b128 v[72:75], v124 offset:1024
    v_exp_f32 v40, v40
    v_exp_f32 v41, v41
    v_add_u32 v125, s39, v125
    v_cvt_pk_bf16_f32 v12, v36, v37
    v_cvt_pk_bf16_f32 v13, v38, v39
    v_exp_f32 v42, v42
    v_exp_f32 v43, v43
    v_mfma_f32_32x32x8_bf16 v[52:67], v[106:107], v[8:9], v[52:67]
    v_exp_f32 v44, v44
    v_exp_f32 v45, v45
    v_cvt_pk_bf16_f32 v14, v40, v41
    v_cvt_pk_bf16_f32 v15, v42, v43
    v_exp_f32 v46, v46
    v_exp_f32 v47, v47
    v_mfma_f32_32x32x16_bf16 v[20:35], v[116:119], v[16:19], v[20:35]
    ds_read_b128 v[92:95], v125 offset:0
    v_exp_f32 v48, v48
    v_exp_f32 v49, v49
    v_cvt_pk_bf16_f32 v16, v44, v45
    v_cvt_pk_bf16_f32 v17, v46, v47
    v_exp_f32 v50, v50
    v_exp_f32 v51, v51
    v_mfma_f32_32x32x16_bf16 v[20:35], v[120:123], v[12:15], v[20:35]
    s_add_u32 s37, s37, 1
    s_cmp_lt_u32 s37, 8
    v_cvt_pk_bf16_f32 v18, v48, v49
    v_exp_f32 v52, v52
    v_exp_f32 v53, v53
    v_cvt_pk_bf16_f32 v19, v50, v51
    v_exp_f32 v54, v54
    v_exp_f32 v55, v55
    s_waitcnt lgkmcnt(0)
    v_mfma_f32_32x32x16_bf16 v[36:51], v[68:71], v[4:7], 0
    ds_read_b128 v[108:111], v125 offset:768
    ds_read_b128 v[112:115], v125 offset:1536
    v_exp_f32 v56, v56
    v_exp_f32 v57, v57
    v_cvt_pk_bf16_f32 v12, v52, v53
    v_cvt_pk_bf16_f32 v13, v54, v55
    v_exp_f32 v58, v58
    v_exp_f32 v59, v59
    v_mfma_f32_32x32x8_bf16 v[36:51], v[76:77], v[8:9], v[36:51]
    v_exp_f32 v60, v60
    v_exp_f32 v61, v61
    v_cvt_pk_bf16_f32 v14, v56, v57
    v_cvt_pk_bf16_f32 v15, v58, v59
    v_exp_f32 v62, v62
    v_exp_f32 v63, v63
    v_mfma_f32_32x32x16_bf16 v[20:35], v[80:83], v[16:19], v[20:35]
    ds_read_b128 v[96:99], v124 offset:6144
    v_exp_f32 v64, v64
    v_exp_f32 v65, v65
    v_cvt_pk_bf16_f32 v16, v60, v61
    v_cvt_pk_bf16_f32 v17, v62, v63
    v_exp_f32 v66, v66
    v_exp_f32 v67, v67
    v_mfma_f32_32x32x16_bf16 v[20:35], v[84:87], v[12:15], v[20:35]
    ds_read_b128 v[104:107], v124 offset:8192
    s_cbranch_scc1 B_loop
    v_cvt_pk_bf16_f32 v18, v64, v65
    v_cvt_pk_bf16_f32 v19, v66, v67
    s_nop 1
    v_mfma_f32_32x32x16_bf16 v[20:35], v[88:91], v[16:19], v[20:35]
    ds_read_b32 v139, v137
    s_waitcnt lgkmcnt(0)
    v_mov_b32 v132, 0x5d800000
    s_lshl_b32 s41, s64, 3
    s_add_u32 s41, s41, s32
    s_mul_i32 s41, s41, 1280
    s_add_u32 s41, s41, 11534336
    v_lshlrev_b32 v126, 4, v0
    v_lshlrev_b32 v127, 3, v0
    s_nop 2
    v_mov_b32 v130, v28
    v_mov_b32 v131, v28
    s_nop 1
    v_permlane32_swap_b32 v130, v131
    v_cmp_nle_f32 vcc, 0x21800000, v131
    v_cmp_nle_f32 s[52:53], v131, v132
    s_nop 0
    s_or_b64 s[52:53], s[52:53], vcc
    s_cbranch_scc1 B_fallback
B_norm:
    v_rcp_f32 v130, v131
    s_nop 0
    v_mul_f32 v20, v130, v20
    v_mul_f32 v21, v130, v21
    v_mul_f32 v22, v130, v22
    v_mul_f32 v23, v130, v23
    v_mul_f32 v24, v130, v24
    v_mul_f32 v25, v130, v25
    v_mul_f32 v26, v130, v26
    v_mul_f32 v27, v130, v27
    v_mul_f32 v28, v130, v28
    v_mul_f32 v29, v130, v29
    v_mul_f32 v30, v130, v30
    v_mul_f32 v31, v130, v31
    v_cvt_pk_bf16_f32 v20, v20, v21
    v_cvt_pk_bf16_f32 v21, v22, v23
    v_cvt_pk_bf16_f32 v22, v24, v25
    v_cvt_pk_bf16_f32 v23, v26, v27
    v_cvt_pk_bf16_f32 v24, v28, v29
    v_cvt_pk_bf16_f32 v25, v30, v31
    v_readlane_b32 s35, v139, 9
    s_nop 0
    s_cmp_eq_u32 s35, 4
    s_cbranch_scc1 B_near
    buffer_store_dwordx4 v[20:23], v126, s[12:15], s41 offen sc1
    s_mov_b32 exec_hi, 0
    buffer_store_dwordx2 v[24:25], v127, s[12:15], s41 offen offset:1024 sc1
    s_branch B_done
B_near:
    buffer_store_dwordx4 v[20:23], v126, s[12:15], s41 offen
    s_mov_b32 exec_hi, 0
    buffer_store_dwordx2 v[24:25], v127, s[12:15], s41 offen offset:1024
B_done:
    ds_add_u32 v137, v138
    s_endpgm
B_prio:
    s_setprio 1
    s_cmp_eq_u32 s37, 2
    s_cbranch_scc1 B_prioret
    s_setprio 0
    s_cmp_eq_u32 s37, 6
    s_cbranch_scc1 B_prioret
    s_branch B_prioret
B_spin:
    s_mov_b32 s42, 800000
B_spin1:
    s_sleep 4
    ds_read_b32 v139, v137 offset:256
    s_waitcnt lgkmcnt(0)
    v_readlane_b32 s35, v139, s37
    s_nop 0
    s_cmp_ge_u32 s35, 4
    s_cbranch_scc1 B_synced
    s_sub_u32 s42, s42, 1
    s_cmp_lg_u32 s42, 0
    s_cbranch_scc1 B_spin1
    s_branch B_synced
B_fallback:
    s_mov_b32 exec_lo, 0
    v_mov_b32 v8, 0
    s_mov_b32 exec_lo, -1
    s_add_u32 s38, s38, 61440
    v_subrev_u32 v124, s38, v124
    v_subrev_u32 v125, s38, v125
    v_mov_b32 v130, 0xff800000
    v_mov_b32 v20, 0
    v_mov_b32 v21, 0
    v_mov_b32 v22, 0
    v_mov_b32 v23, 0
    v_mov_b32 v24, 0
    v_mov_b32 v25, 0
    v_mov_b32 v26, 0
    v_mov_b32 v27, 0
    v_mov_b32 v28, 0
    v_mov_b32 v29, 0
    v_mov_b32 v30, 0
    v_mov_b32 v31, 0
    v_mov_b32 v32, 0
    v_mov_b32 v33, 0
    v_mov_b32 v34, 0
    v_mov_b32 v35, 0
    s_mov_b32 s44, 10485760
B_fb1:
    buffer_load_dwordx4 v[68:71], v124, s[12:15], s44 offen offset:0 sc1
    buffer_load_dwordx4 v[72:75], v124, s[12:15], s44 offen offset:1024 sc1
    buffer_load_dwordx4 v[76:79], v124, s[12:15], s44 offen offset:2048 sc1
    s_waitcnt vmcnt(0)
    v_mfma_f32_32x32x16_bf16 v[36:51], v[68:71], v[4:7], 0
    v_mfma_f32_32x32x8_bf16 v[36:51], v[76:77], v[8:9], v[36:51]
    v_mfma_f32_32x32x16_bf16 v[52:67], v[72:75], v[4:7], 0
    v_mfma_f32_32x32x8_bf16 v[52:67], v[78:79], v[8:9], v[52:67]
    s_nop 9
    v_max3_f32 v130, v130, v36, v37
    v_max3_f32 v130, v130, v38, v39
    v_max3_f32 v130, v130, v40, v41
    v_max3_f32 v130, v130, v42, v43
    v_max3_f32 v130, v130, v44, v45
    v_max3_f32 v130, v130, v46, v47
    v_max3_f32 v130, v130, v48, v49
    v_max3_f32 v130, v130, v50, v51
    v_max3_f32 v130, v130, v52, v53
    v_max3_f32 v130, v130, v54, v55
    v_max3_f32 v130, v130, v56, v57
    v_max3_f32 v130, v130, v58, v59
    v_max3_f32 v130, v130, v60, v61
    v_max3_f32 v130, v130, v62, v63
    v_max3_f32 v130, v130, v64, v65
    v_max3_f32 v130, v130, v66, v67
    s_add_u32 s44, s44, 6144
    s_cmp_lt_u32 s44, 10682368
    s_cbranch_scc1 B_fb1
    v_mov_b32 v131, v130
    s_nop 1
    v_permlane32_swap_b32 v130, v131
    v_max_f32 v130, v130, v131
    s_mov_b32 s44, 10485760
B_fb2:
    buffer_load_dwordx4 v[68:71], v124, s[12:15], s44 offen offset:0 sc1
    buffer_load_dwordx4 v[72:75], v124, s[12:15], s44 offen offset:1024 sc1
    buffer_load_dwordx4 v[76:79], v124, s[12:15], s44 offen offset:2048 sc1
    buffer_load_dwordx4 v[80:83], v125, s[12:15], s44 offen offset:0 sc1
    buffer_load_dwordx4 v[84:87], v125, s[12:15], s44 offen offset:768 sc1
    buffer_load_dwordx4 v[88:91], v125, s[12:15], s44 offen offset:1536 sc1
    buffer_load_dwordx4 v[92:95], v125, s[12:15], s44 offen offset:2304 sc1
    s_waitcnt vmcnt(0)
    v_mfma_f32_32x32x16_bf16 v[36:51], v[68:71], v[4:7], 0
    v_mfma_f32_32x32x8_bf16 v[36:51], v[76:77], v[8:9], v[36:51]
    v_mfma_f32_32x32x16_bf16 v[52:67], v[72:75], v[4:7], 0
    v_mfma_f32_32x32x8_bf16 v[52:67], v[78:79], v[8:9], v[52:67]
    s_nop 9
    v_sub_f32 v36, v36, v130
    v_sub_f32 v37, v37, v130
    v_sub_f32 v38, v38, v130
    v_sub_f32 v39, v39, v130
    v_sub_f32 v40, v40, v130
    v_sub_f32 v41, v41, v130
    v_sub_f32 v42, v42, v130
    v_sub_f32 v43, v43, v130
    v_sub_f32 v44, v44, v130
    v_sub_f32 v45, v45, v130
    v_sub_f32 v46, v46, v130
    v_sub_f32 v47, v47, v130
    v_sub_f32 v48, v48, v130
    v_sub_f32 v49, v49, v130
    v_sub_f32 v50, v50, v130
    v_sub_f32 v51, v51, v130
    v_exp_f32 v36, v36
    v_exp_f32 v37, v37
    v_exp_f32 v38, v38
    v_exp_f32 v39, v39
    v_exp_f32 v40, v40
    v_exp_f32 v41, v41
    v_exp_f32 v42, v42
    v_exp_f32 v43, v43
    v_exp_f32 v44, v44
    v_exp_f32 v45, v45
    v_exp_f32 v46, v46
    v_exp_f32 v47, v47
    v_exp_f32 v48, v48
    v_exp_f32 v49, v49
    v_exp_f32 v50, v50
    v_exp_f32 v51, v51
    v_cvt_pk_bf16_f32 v12, v36, v37
    v_cvt_pk_bf16_f32 v13, v38, v39
    v_cvt_pk_bf16_f32 v14, v40, v41
    v_cvt_pk_bf16_f32 v15, v42, v43
    v_cvt_pk_bf16_f32 v16, v44, v45
    v_cvt_pk_bf16_f32 v17, v46, v47
    v_cvt_pk_bf16_f32 v18, v48, v49
    v_cvt_pk_bf16_f32 v19, v50, v51
    v_mfma_f32_32x32x16_bf16 v[20:35], v[80:83], v[12:15], v[20:35]
    s_nop 0
    v_mfma_f32_32x32x16_bf16 v[20:35], v[84:87], v[16:19], v[20:35]
    v_sub_f32 v52, v52, v130
    v_sub_f32 v53, v53, v130
    v_sub_f32 v54, v54, v130
    v_sub_f32 v55, v55, v130
    v_sub_f32 v56, v56, v130
    v_sub_f32 v57, v57, v130
    v_sub_f32 v58, v58, v130
    v_sub_f32 v59, v59, v130
    v_sub_f32 v60, v60, v130
    v_sub_f32 v61, v61, v130
    v_sub_f32 v62, v62, v130
    v_sub_f32 v63, v63, v130
    v_sub_f32 v64, v64, v130
    v_sub_f32 v65, v65, v130
    v_sub_f32 v66, v66, v130
    v_sub_f32 v67, v67, v130
    v_exp_f32 v52, v52
    v_exp_f32 v53, v53
    v_exp_f32 v54, v54
    v_exp_f32 v55, v55
    v_exp_f32 v56, v56
    v_exp_f32 v57, v57
    v_exp_f32 v58, v58
    v_exp_f32 v59, v59
    v_exp_f32 v60, v60
    v_exp_f32 v61, v61
    v_exp_f32 v62, v62
    v_exp_f32 v63, v63
    v_exp_f32 v64, v64
    v_exp_f32 v65, v65
    v_exp_f32 v66, v66
    v_exp_f32 v67, v67
    v_cvt_pk_bf16_f32 v12, v52, v53
    v_cvt_pk_bf16_f32 v13, v54, v55
    v_cvt_pk_bf16_f32 v14, v56, v57
    v_cvt_pk_bf16_f32 v15, v58, v59
    v_cvt_pk_bf16_f32 v16, v60, v61
    v_cvt_pk_bf16_f32 v17, v62, v63
    v_cvt_pk_bf16_f32 v18, v64, v65
    v_cvt_pk_bf16_f32 v19, v66, v67
    v_mfma_f32_32x32x16_bf16 v[20:35], v[88:91], v[12:15], v[20:35]
    s_nop 0
    v_mfma_f32_32x32x16_bf16 v[20:35], v[92:95], v[16:19], v[20:35]
    s_add_u32 s44, s44, 6144
    s_cmp_lt_u32 s44, 10682368
    s_cbranch_scc1 B_fb2
    s_nop 8
    v_mov_b32 v130, v28
    v_mov_b32 v131, v28
    s_nop 1
    v_permlane32_swap_b32 v130, v131
    s_nop 1
    s_branch B_norm
F_pub:
    s_waitcnt vmcnt(0)
    s_mov_b64 exec, 1
    v_mov_b32 v1, 162816
    v_mov_b32 v2, 1
    ds_add_rtn_u32 v2, v1, v2
    s_lshl_b32 s35, s3, 7
    s_add_u32 s35, s35, 19922944
    v_mov_b32 v1, 0
    v_mov_b32 v3, 1
    s_waitcnt lgkmcnt(0)
    v_readfirstlane_b32 s36, v2
    s_nop 0
    s_cmp_lg_u32 s36, 3
    s_cbranch_scc1 F_pub2
    buffer_store_dword v3, v1, s[12:15], s35 offen sc1
F_pub2:
    s_mov_b64 exec, -1
    v_mov_b32 v2, 162816
    s_mov_b32 s42, 800000
F_all:
    ds_read_b32 v3, v2
    s_waitcnt lgkmcnt(0)
    v_readfirstlane_b32 s35, v3
    s_nop 0
    s_cmp_ge_u32 s35, 4
    s_cbranch_scc1 F_all_ok
    s_sleep 1
    s_sub_u32 s42, s42, 1
    s_cmp_lg_u32 s42, 0
    s_cbranch_scc1 F_all
F_all_ok:
F_gemm0:
    s_mov_b32 s53, -1
F_gemm:
    s_setprio 3
    s_cmp_eq_u32 s53, -1
    s_cbranch_scc1 G_start
    v_mov_b32 v2, 162824
    s_mov_b32 s42, 800000
G_wait0:
    ds_read_b32 v3, v2
    s_waitcnt lgkmcnt(0)
    v_readfirstlane_b32 s35, v3
    s_nop 0
    s_cmp_ge_u32 s35, 4
    s_cbranch_scc1 G_wait0_ok
    s_sleep 1
    s_sub_u32 s42, s42, 1
    s_cmp_lg_u32 s42, 0
    s_cbranch_scc1 G_wait0
G_wait0_ok:
    buffer_store_dwordx4 v[72:75], v1, s[12:15], s53 offen offset:0 sc1
    buffer_store_dwordx4 v[76:79], v1, s[12:15], s53 offen offset:1024 sc1
    buffer_store_dwordx4 v[80:83], v1, s[12:15], s53 offen offset:2048 sc1
    buffer_store_dwordx4 v[84:87], v1, s[12:15], s53 offen offset:3072 sc1
    s_add_u32 s53, s53, 4096
    buffer_store_dwordx4 v[88:91], v1, s[12:15], s53 offen offset:0 sc1
    buffer_store_dwordx4 v[92:95], v1, s[12:15], s53 offen offset:1024 sc1
    s_add_u32 s53, s53, 147456
    buffer_store_dwordx4 v[96:99], v1, s[12:15], s53 offen offset:0 sc1
    buffer_store_dwordx4 v[100:103], v1, s[12:15], s53 offen offset:1024 sc1
    buffer_store_dwordx4 v[104:107], v1, s[12:15], s53 offen offset:2048 sc1
    buffer_store_dwordx4 v[108:111], v1, s[12:15], s53 offen offset:3072 sc1
    s_add_u32 s53, s53, 4096
    buffer_store_dwordx4 v[112:115], v1, s[12:15], s53 offen offset:0 sc1
    buffer_store_dwordx4 v[116:119], v1, s[12:15], s53 offen offset:1024 sc1
G_start:
    s_and_b32 s64, s2, 1
    s_lshl_b32 s64, s64, 3
    s_lshr_b32 s35, s2, 5
    s_add_u32 s64, s64, s35
    s_lshl_b32 s64, s64, 2
    s_bfe_u32 s35, s2, 0x20001
    s_add_u32 s64, s64, s35
    s_lshl_b32 s64, s64, 2
    s_bfe_u32 s35, s2, 0x20003
    s_add_u32 s64, s64, s35
    s_lshr_b32 s33, s64, 2
    s_and_b32 s34, s64, 3
    s_sub_u32 s32, s32, 8
    s_mov_b32 s8, s56
    s_and_b32 s9, s57, 0xffff
    s_mov_b32 s10, 2211840
    s_mov_b32 s11, 0x20000
    s_mov_b32 s16, s58
    s_and_b32 s17, s59, 0xffff
    s_mov_b32 s18, 819200
    s_mov_b32 s19, 0x20000
    s_mov_b32 s20, s60
    s_and_b32 s21, s61, 0xffff
    s_mov_b32 s22, 2621440
    s_mov_b32 s23, 0x20000
    s_mul_i32 s43, s32, 6144
    s_getreg_b32 s39, hwreg(HW_REG_XCC_ID, 0, 4)
    s_add_u32 s39, s39, 16
    s_mov_b32 s41, 0
    s_mul_i32 s46, s32, 15360
    s_add_u32 s46, s46, 0
    s_mul_i32 s47, s32, 552960
    s_mul_i32 s49, s34, 320
    s_add_u32 s47, s47, s49
    s_mul_i32 s48, s32, 27648
    s_add_u32 s48, s48, s41
    v_lshlrev_b32 v9, 4, v0
    v_add_u32 v1, 0, v0
    v_mul_u32_u24 v2, 0xcccd, v1
    v_lshrrev_b32 v2, 20, v2
    v_mul_u32_u24 v3, 20, v2
    v_sub_u32 v3, v1, v3
    v_mul_u32_u24 v2, 1280, v2
    v_lshl_add_u32 v4, v3, 4, v2
    v_add_u32 v1, 64, v0
    v_mul_u32_u24 v2, 0xcccd, v1
    v_lshrrev_b32 v2, 20, v2
    v_mul_u32_u24 v3, 20, v2
    v_sub_u32 v3, v1, v3
    v_mul_u32_u24 v2, 1280, v2
    v_lshl_add_u32 v5, v3, 4, v2
    v_subrev_u32 v5, 1024, v5
    v_add_u32 v1, 128, v0
    v_mul_u32_u24 v2, 0xcccd, v1
    v_lshrrev_b32 v2, 20, v2
    v_mul_u32_u24 v3, 20, v2
    v_sub_u32 v3, v1, v3
    v_mul_u32_u24 v2, 1280, v2
    v_lshl_add_u32 v6, v3, 4, v2
    v_subrev_u32 v6, 2048, v6
    v_add_u32 v1, 192, v0
    v_mul_u32_u24 v2, 0xcccd, v1
    v_lshrrev_b32 v2, 20, v2
    v_mul_u32_u24 v3, 20, v2
    v_sub_u32 v3, v1, v3
    v_mul_u32_u24 v2, 1280, v2
    v_lshl_add_u32 v7, v3, 4, v2
    v_subrev_u32 v7, 3072, v7
    v_add_u32 v1, 256, v0
    v_mul_u32_u24 v2, 0xcccd, v1
    v_lshrrev_b32 v2, 20, v2
    v_mul_u32_u24 v3, 20, v2
    v_sub_u32 v3, v1, v3
    v_mul_u32_u24 v2, 1280, v2
    v_lshl_add_u32 v8, v3, 4, v2
    s_and_b32 s36, s33, 3
    s_lshl_b32 s37, s36, 2
    s_min_u32 s35, s36, 2
    s_mul_i32 s50, s35, 27
    s_cmp_eq_u32 s36, 3
    s_cselect_b32 s35, 27, 0
    s_add_u32 s50, s50, s35
    s_cmp_lt_u32 s36, 2
    s_cselect_b32 s52, 27, 27
    s_mul_i32 s54, s50, 20480
    s_mul_i32 s35, s34, 320
    s_add_u32 s54, s54, s35
    s_mul_i32 s45, s32, 204800
    s_add_u32 s45, s45, s35
    s_and_b32 s38, s33, 0xfc
    s_add_u32 s38, s38, s32
    s_mul_i32 s55, s38, 151552
    s_lshl_b32 s35, s50, 10
    s_add_u32 s55, s55, s35
    s_add_u32 s55, s55, 40960
    v_mul_u32_u24 v2, 12, v0
    s_sub_u32 s35, s52, 1
    v_min_u32 v2, s35, v2
    v_add_u32 v2, s50, v2
    v_mul_u32_u24 v2, 0x5556, v2
    v_lshrrev_b32 v2, 18, v2
    s_lshr_b32 s35, s33, 2
    v_mov_b32 v1, s35
    v_lshl_add_u32 v157, v1, 4, v2
    v_lshlrev_b32 v157, 7, v157
    v_add_u32 v157, 19922944, v157
    s_bfe_u32 s51, s33, 65538
    s_lshr_b32 s35, s52, 1
    s_mul_i32 s51, s51, s35
    s_add_u32 s50, s51, s32
    v_lshrrev_b32 v2, 5, v0
    v_bfe_u32 v1, v0, 2, 2
    v_lshl_add_u32 v1, v2, 2, v1
    v_mul_u32_u24 v1, 320, v1
    v_bfe_u32 v3, v0, 4, 1
    v_lshl_add_u32 v1, v3, 5, v1
    v_and_b32 v3, 3, v0
    v_lshl_add_u32 v1, v3, 3, v1
    v_add_u32 v10, s46, v1
    v_subrev_u32 v10, s46, v10
    v_add_u32 v1, 0, v0
    v_mul_u32_u24 v2, 0xcccd, v1
    v_lshrrev_b32 v2, 22, v2
    v_mul_u32_u24 v2, 20480, v2
    v_add_u32 v152, v2, v4
    v_add_u32 v1, 64, v0
    v_mul_u32_u24 v2, 0xcccd, v1
    v_lshrrev_b32 v2, 22, v2
    v_mul_u32_u24 v2, 20480, v2
    v_add_u32 v153, v2, v5
    v_add_u32 v1, 128, v0
    v_mul_u32_u24 v2, 0xcccd, v1
    v_lshrrev_b32 v2, 22, v2
    v_mul_u32_u24 v2, 20480, v2
    v_add_u32 v154, v2, v6
    v_add_u32 v1, 192, v0
    v_mul_u32_u24 v2, 0xcccd, v1
    v_lshrrev_b32 v2, 22, v2
    v_mul_u32_u24 v2, 20480, v2
    v_add_u32 v155, v2, v7
    v_add_u32 v1, 256, v0
    v_mul_u32_u24 v2, 0xcccd, v1
    v_lshrrev_b32 v2, 22, v2
    v_mul_u32_u24 v2, 20480, v2
    v_add_u32 v156, v2, v8
    v_mov_b32 v2, 162824
    s_mov_b32 s42, 800000
G_wait:
    ds_read_b32 v3, v2
    s_waitcnt lgkmcnt(0)
    v_readfirstlane_b32 s35, v3
    s_nop 0
    s_cmp_ge_u32 s35, 8
    s_cbranch_scc1 G_wait_ok
    s_sleep 1
    s_sub_u32 s42, s42, 1
    s_cmp_lg_u32 s42, 0
    s_cbranch_scc1 G_wait
G_wait_ok:
    s_mov_b64 exec, 1
    v_mov_b32 v2, 163328
    v_mov_b32 v3, 1
    ds_add_u32 v2, v3
    s_mov_b64 exec, -1
    s_mov_b64 exec, 1
    v_mov_b32 v2, 163332
    v_mov_b32 v3, 1
    ds_add_u32 v2, v3
    s_mov_b64 exec, -1
    v_mov_b32 v2, 14
    v_lshl_add_u32 v52, v0, 4, v2
    v_lshlrev_b32 v52, 7, v52
    v_add_u32 v52, 19922944, v52
    s_mov_b32 exec_lo, 0xffff
    s_mov_b32 exec_hi, 0
    s_mov_b32 s42, 20000
    buffer_load_dword v53, v52, s[12:15], 0 offen sc1
    s_mov_b64 exec, -1
    s_cmp_ge_u32 s50, s52
    s_cselect_b32 s35, s52, 0
    s_sub_u32 s50, s50, s35
    s_mul_i32 s47, s50, 20480
    s_add_u32 s47, s47, s54
    s_add_u32 s50, s50, 4
    s_movk_i32 s35, 0
    s_cmp_ge_u32 s37, 8
    s_cselect_b32 s35, 0, s35
    s_add_u32 m0, s46, s35
    s_nop 0
    buffer_load_dwordx4 v4, s[8:11], s47 offen offset:0 lds
    buffer_load_dwordx4 v5, s[8:11], s47 offen offset:1024 lds
    buffer_load_dwordx4 v6, s[8:11], s47 offen offset:2048 lds
    buffer_load_dwordx4 v7, s[8:11], s47 offen offset:3072 lds
    s_add_u32 m0, m0, 4096
    s_nop 0
    buffer_load_dwordx4 v8, s[8:11], s47 offen lds
    s_cmp_ge_u32 s50, s52
    s_cselect_b32 s35, s52, 0
    s_sub_u32 s50, s50, s35
    s_mul_i32 s47, s50, 20480
    s_add_u32 s47, s47, s54
    s_add_u32 s50, s50, 4
    s_movk_i32 s35, 5120
    s_cmp_ge_u32 s37, 8
    s_cselect_b32 s35, 5120, s35
    s_add_u32 m0, s46, s35
    s_nop 0
    buffer_load_dwordx4 v4, s[8:11], s47 offen offset:0 lds
    buffer_load_dwordx4 v5, s[8:11], s47 offen offset:1024 lds
    buffer_load_dwordx4 v6, s[8:11], s47 offen offset:2048 lds
    buffer_load_dwordx4 v7, s[8:11], s47 offen offset:3072 lds
    s_add_u32 m0, m0, 4096
    s_nop 0
    buffer_load_dwordx4 v8, s[8:11], s47 offen lds
    s_cmp_eq_u32 s53, -1
    s_cbranch_scc1 G_noh
    s_waitcnt vmcnt(11)
    s_mov_b64 exec, 1
    v_mov_b32 v1, 162816
    v_mov_b32 v2, 1
    ds_add_rtn_u32 v2, v1, v2
    s_lshl_b32 s35, s3, 7
    s_add_u32 s35, s35, 19922944
    v_mov_b32 v1, 0
    v_mov_b32 v3, 1
    s_waitcnt lgkmcnt(0)
    v_readfirstlane_b32 s36, v2
    s_nop 0
    s_cmp_lg_u32 s36, 3
    s_cbranch_scc1 G_pub
    buffer_store_dword v3, v1, s[12:15], s35 offen sc1
G_pub:
    s_mov_b64 exec, -1
G_noh:
    s_mov_b32 exec_lo, 0xffff
    s_mov_b32 exec_hi, 0
    s_branch G_pollkv_chk
G_pollkv:
    buffer_load_dword v53, v52, s[12:15], 0 offen sc1
G_pollkv_chk:
    s_waitcnt vmcnt(0)
    v_cmp_gt_u32 vcc, 1, v53
    s_nop 0
    s_cmp_eq_u64 vcc, 0
    s_cbranch_scc1 G_pollkv_ok
    s_sleep 6
    s_sub_u32 s42, s42, 1
    s_cmp_lg_u32 s42, 0
    s_cbranch_scc1 G_pollkv
G_pollkv_ok:
    s_mov_b64 exec, -1
    s_lshr_b32 s44, s33, 3
    s_add_u32 s44, s44, 3
    s_and_b32 s44, s44, 7
    s_mul_i32 s44, s44, 24576
    s_add_u32 s44, s44, s43
    s_add_u32 s44, s44, 10485760
    s_add_u32 m0, s43, 61440
    s_nop 0
    buffer_load_dwordx4 v9, s[12:15], s44 offen offset:0 sc1 lds
    buffer_load_dwordx4 v9, s[12:15], s44 offen offset:1024 sc1 lds
    buffer_load_dwordx4 v9, s[12:15], s44 offen offset:2048 sc1 lds
    buffer_load_dwordx4 v9, s[12:15], s44 offen offset:3072 sc1 lds
    s_add_u32 m0, m0, 4096
    s_add_u32 s44, s44, 4096
    buffer_load_dwordx4 v9, s[12:15], s44 offen offset:0 sc1 lds
    buffer_load_dwordx4 v9, s[12:15], s44 offen offset:1024 sc1 lds
    s_waitcnt vmcnt(0)
    s_mov_b64 exec, 1
    v_mov_b32 v2, 163336
    v_mov_b32 v3, 1
    ds_add_u32 v2, v3
    s_mov_b64 exec, -1
    s_mov_b64 exec, 15
    s_mov_b32 s42, 20000
G_pollh:
    buffer_load_dword v2, v157, s[12:15], 0 offen sc1
    s_waitcnt vmcnt(0)
    v_cmp_gt_u32 vcc, 1, v2
    s_nop 0
    s_cmp_eq_u64 vcc, 0
    s_cbranch_scc1 G_pollh_ok
    s_sleep 4
    s_sub_u32 s42, s42, 1
    s_cmp_lg_u32 s42, 0
    s_cbranch_scc1 G_pollh
G_pollh_ok:
    s_mov_b64 exec, -1
    s_lshl_b32 s48, s51, 10
    s_add_u32 s48, s48, s55
    s_add_u32 s51, s51, 1
    s_cmp_eq_u32 s51, s52
    s_cselect_b32 s51, 0, s51
    buffer_load_dwordx4 v[12:15], v9, s[12:15], s48 offen sc1
    s_lshl_b32 s48, s51, 10
    s_add_u32 s48, s48, s55
    s_add_u32 s51, s51, 1
    s_cmp_eq_u32 s51, s52
    s_cselect_b32 s51, 0, s51
    buffer_load_dwordx4 v[16:19], v9, s[12:15], s48 offen sc1
    s_lshl_b32 s48, s51, 10
    s_add_u32 s48, s48, s55
    s_add_u32 s51, s51, 1
    s_cmp_eq_u32 s51, s52
    s_cselect_b32 s51, 0, s51
    buffer_load_dwordx4 v[20:23], v9, s[12:15], s48 offen sc1
    s_lshl_b32 s48, s51, 10
    s_add_u32 s48, s48, s55
    s_add_u32 s51, s51, 1
    s_cmp_eq_u32 s51, s52
    s_cselect_b32 s51, 0, s51
    buffer_load_dwordx4 v[24:27], v9, s[12:15], s48 offen sc1
    s_cmp_ge_u32 s50, s52
    s_cselect_b32 s35, s52, 0
    s_sub_u32 s50, s50, s35
    s_mul_i32 s47, s50, 20480
    s_add_u32 s47, s47, s54
    s_add_u32 s50, s50, 4
    s_movk_i32 s35, 10240
    s_cmp_ge_u32 s37, 8
    s_cselect_b32 s35, 10240, s35
    s_add_u32 m0, s46, s35
    s_nop 0
    buffer_load_dwordx4 v4, s[8:11], s47 offen offset:0 lds
    buffer_load_dwordx4 v5, s[8:11], s47 offen offset:1024 lds
    buffer_load_dwordx4 v6, s[8:11], s47 offen offset:2048 lds
    buffer_load_dwordx4 v7, s[8:11], s47 offen offset:3072 lds
    s_add_u32 m0, m0, 4096
    s_nop 0
    buffer_load_dwordx4 v8, s[8:11], s47 offen lds
    s_lshl_b32 s48, s51, 10
    s_add_u32 s48, s48, s55
    s_add_u32 s51, s51, 1
    s_cmp_eq_u32 s51, s52
    s_cselect_b32 s51, 0, s51
    buffer_load_dwordx4 v[28:31], v9, s[12:15], s48 offen sc1
    s_lshl_b32 s48, s51, 10
    s_add_u32 s48, s48, s55
    s_add_u32 s51, s51, 1
    s_cmp_eq_u32 s51, s52
    s_cselect_b32 s51, 0, s51
    buffer_load_dwordx4 v[32:35], v9, s[12:15], s48 offen sc1
    s_lshl_b32 s48, s51, 10
    s_add_u32 s48, s48, s55
    s_add_u32 s51, s51, 1
    s_cmp_eq_u32 s51, s52
    s_cselect_b32 s51, 0, s51
    buffer_load_dwordx4 v[36:39], v9, s[12:15], s48 offen sc1
    s_lshl_b32 s48, s51, 10
    s_add_u32 s48, s48, s55
    s_add_u32 s51, s51, 1
    s_cmp_eq_u32 s51, s52
    s_cselect_b32 s51, 0, s51
    buffer_load_dwordx4 v[40:43], v9, s[12:15], s48 offen sc1
    v_mov_b32 v157, v0
    s_mul_i32 s41, s33, 40960
    s_mul_i32 s35, s34, 320
    s_add_u32 s41, s41, s35
    s_mul_i32 s35, s32, 10240
    s_add_u32 s41, s41, s35
    v_and_b32 v1, 31, v0
    v_lshrrev_b32 v2, 5, v0
    v_mul_u32_u24 v11, 1280, v2
    v_lshl_add_u32 v11, v1, 3, v11
    v_mul_u32_u24 v1, 0xcccd, v0
    v_lshrrev_b32 v1, 18, v1
    v_mul_u32_u24 v2, 5, v1
    v_sub_u32 v2, v0, v2
    v_mul_u32_u24 v1, 1280, v1
    v_lshl_add_u32 v158, v2, 6, v1
    s_mul_i32 s35, s32, 5120
    s_add_u32 s35, s35, 86016
    v_add_u32 v0, s35, v10
    v_mov_b32 v162, -1
    v_mov_b32 v163, -1
    v_mov_b32 v164, -1
    v_mov_b32 v165, -1
    s_mov_b64 exec, 1
    v_mov_b32 v2, 162848
    v_mov_b32 v3, 1
    ds_add_u32 v2, v3
    s_mov_b64 exec, -1
    v_mov_b32 v2, 162848
    s_mov_b32 s42, 800000
G_sync0:
    ds_read_b32 v3, v2
    s_waitcnt lgkmcnt(0)
    v_readfirstlane_b32 s35, v3
    s_nop 0
    s_cmp_ge_u32 s35, 4
    s_cbranch_scc1 G_sync0_ok
    s_sleep 1
    s_sub_u32 s42, s42, 1
    s_cmp_lg_u32 s42, 0
    s_cbranch_scc1 G_sync0
G_sync0_ok:
    ds_read_b64_tr_b16 v[52:53], v10 offset:0
    ds_read_b64_tr_b16 v[54:55], v10 offset:2560
    ds_read_b64_tr_b16 v[56:57], v10 offset:64
    ds_read_b64_tr_b16 v[58:59], v10 offset:2624
    ds_read_b64_tr_b16 v[60:61], v10 offset:128
    ds_read_b64_tr_b16 v[62:63], v10 offset:2688
    ds_read_b64_tr_b16 v[64:65], v10 offset:192
    ds_read_b64_tr_b16 v[66:67], v10 offset:2752
    ds_read_b64_tr_b16 v[68:69], v10 offset:256
    ds_read_b64_tr_b16 v[70:71], v10 offset:2816
    s_waitcnt vmcnt(12)
    s_setprio 0
    s_waitcnt lgkmcnt(8)
    v_mfma_f32_32x32x16_bf16 v[72:87], v[52:55], v[12:15], 0
    ds_read_b64_tr_b16 v[52:53], v10 offset:15360
    ds_read_b64_tr_b16 v[54:55], v10 offset:17920
    s_waitcnt lgkmcnt(8)
    v_mfma_f32_32x32x16_bf16 v[88:103], v[56:59], v[12:15], 0
    ds_read_b64_tr_b16 v[56:57], v10 offset:15424
    ds_read_b64_tr_b16 v[58:59], v10 offset:17984
    s_setprio 3
    s_waitcnt lgkmcnt(8)
    v_mfma_f32_32x32x16_bf16 v[104:119], v[60:63], v[12:15], 0
    ds_read_b64_tr_b16 v[60:61], v10 offset:15488
    ds_read_b64_tr_b16 v[62:63], v10 offset:18048
    s_setprio 0
    s_waitcnt lgkmcnt(8)
    v_mfma_f32_32x32x16_bf16 v[120:135], v[64:67], v[12:15], 0
    ds_read_b64_tr_b16 v[64:65], v10 offset:15552
    ds_read_b64_tr_b16 v[66:67], v10 offset:18112
    s_waitcnt lgkmcnt(8)
    v_mfma_f32_32x32x16_bf16 v[136:151], v[68:71], v[12:15], 0
    ds_read_b64_tr_b16 v[68:69], v10 offset:15616
    ds_read_b64_tr_b16 v[70:71], v10 offset:18176
    s_setprio 3
    s_waitcnt vmcnt(11)
    s_setprio 0
    s_waitcnt lgkmcnt(8)
    v_mfma_f32_32x32x16_bf16 v[72:87], v[52:55], v[16:19], v[72:87]
    ds_read_b64_tr_b16 v[52:53], v10 offset:30720
    ds_read_b64_tr_b16 v[54:55], v10 offset:33280
    s_waitcnt lgkmcnt(8)
    v_mfma_f32_32x32x16_bf16 v[88:103], v[56:59], v[16:19], v[88:103]
    ds_read_b64_tr_b16 v[56:57], v10 offset:30784
    ds_read_b64_tr_b16 v[58:59], v10 offset:33344
    s_setprio 3
    s_waitcnt lgkmcnt(8)
    v_mfma_f32_32x32x16_bf16 v[104:119], v[60:63], v[16:19], v[104:119]
    ds_read_b64_tr_b16 v[60:61], v10 offset:30848
    ds_read_b64_tr_b16 v[62:63], v10 offset:33408
    s_setprio 0
    s_waitcnt lgkmcnt(8)
    v_mfma_f32_32x32x16_bf16 v[120:135], v[64:67], v[16:19], v[120:135]
    ds_read_b64_tr_b16 v[64:65], v10 offset:30912
    ds_read_b64_tr_b16 v[66:67], v10 offset:33472
    s_waitcnt lgkmcnt(8)
    v_mfma_f32_32x32x16_bf16 v[136:151], v[68:71], v[16:19], v[136:151]
    ds_read_b64_tr_b16 v[68:69], v10 offset:30976
    ds_read_b64_tr_b16 v[70:71], v10 offset:33536
    s_setprio 3
    s_waitcnt vmcnt(10)
    s_setprio 0
    s_waitcnt lgkmcnt(8)
    v_mfma_f32_32x32x16_bf16 v[72:87], v[52:55], v[20:23], v[72:87]
    ds_read_b64_tr_b16 v[52:53], v10 offset:46080
    ds_read_b64_tr_b16 v[54:55], v10 offset:48640
    s_waitcnt lgkmcnt(8)
    v_mfma_f32_32x32x16_bf16 v[88:103], v[56:59], v[20:23], v[88:103]
    ds_read_b64_tr_b16 v[56:57], v10 offset:46144
    ds_read_b64_tr_b16 v[58:59], v10 offset:48704
    s_setprio 3
    s_waitcnt lgkmcnt(8)
    v_mfma_f32_32x32x16_bf16 v[104:119], v[60:63], v[20:23], v[104:119]
    ds_read_b64_tr_b16 v[60:61], v10 offset:46208
    ds_read_b64_tr_b16 v[62:63], v10 offset:48768
    s_setprio 0
    s_waitcnt lgkmcnt(8)
    v_mfma_f32_32x32x16_bf16 v[120:135], v[64:67], v[20:23], v[120:135]
    ds_read_b64_tr_b16 v[64:65], v10 offset:46272
    ds_read_b64_tr_b16 v[66:67], v10 offset:48832
    s_waitcnt lgkmcnt(8)
    v_mfma_f32_32x32x16_bf16 v[136:151], v[68:71], v[20:23], v[136:151]
    ds_read_b64_tr_b16 v[68:69], v10 offset:46336
    ds_read_b64_tr_b16 v[70:71], v10 offset:48896
    s_setprio 3
    s_mov_b64 exec, 1
    v_mov_b32 v2, 162852
    v_mov_b32 v3, 1
    ds_add_u32 v2, v3
    s_mov_b64 exec, -1
    v_mov_b32 v2, 162852
    s_mov_b32 s42, 800000
G_sync1h:
    ds_read_b32 v3, v2
    s_waitcnt lgkmcnt(0)
    v_readfirstlane_b32 s35, v3
    s_nop 0
    s_cmp_ge_u32 s35, 4
    s_cbranch_scc1 G_sync1h_ok
    s_sleep 1
    s_sub_u32 s42, s42, 1
    s_cmp_lg_u32 s42, 0
    s_cbranch_scc1 G_sync1h
G_sync1h_ok:
    s_cmp_ge_u32 s50, s52
    s_cselect_b32 s35, s52, 0
    s_sub_u32 s50, s50, s35
    s_mul_i32 s47, s50, 20480
    s_add_u32 s47, s47, s54
    s_add_u32 s50, s50, 4
    s_add_u32 m0, s46, 0
    s_nop 0
    buffer_load_dwordx4 v4, s[8:11], s47 offen offset:0 lds
    buffer_load_dwordx4 v5, s[8:11], s47 offen offset:1024 lds
    buffer_load_dwordx4 v6, s[8:11], s47 offen offset:2048 lds
    buffer_load_dwordx4 v7, s[8:11], s47 offen offset:3072 lds
    s_add_u32 m0, m0, 4096
    s_nop 0
    buffer_load_dwordx4 v8, s[8:11], s47 offen lds
    s_waitcnt vmcnt(14)
    s_setprio 0
    v_mfma_f32_32x32x16_bf16 v[72:87], v[52:55], v[24:27], v[72:87]
    ds_read_b64_tr_b16 v[52:53], v10 offset:5120
    ds_read_b64_tr_b16 v[54:55], v10 offset:7680
    v_mfma_f32_32x32x16_bf16 v[88:103], v[56:59], v[24:27], v[88:103]
    ds_read_b64_tr_b16 v[56:57], v10 offset:5184
    ds_read_b64_tr_b16 v[58:59], v10 offset:7744
    s_setprio 3
    v_mfma_f32_32x32x16_bf16 v[104:119], v[60:63], v[24:27], v[104:119]
    ds_read_b64_tr_b16 v[60:61], v10 offset:5248
    ds_read_b64_tr_b16 v[62:63], v10 offset:7808
    s_setprio 0
    v_mfma_f32_32x32x16_bf16 v[120:135], v[64:67], v[24:27], v[120:135]
    ds_read_b64_tr_b16 v[64:65], v10 offset:5312
    ds_read_b64_tr_b16 v[66:67], v10 offset:7872
    v_mfma_f32_32x32x16_bf16 v[136:151], v[68:71], v[24:27], v[136:151]
    ds_read_b64_tr_b16 v[68:69], v10 offset:5376
    ds_read_b64_tr_b16 v[70:71], v10 offset:7936
    s_setprio 3
    s_lshl_b32 s48, s51, 10
    s_add_u32 s48, s48, s55
    s_add_u32 s51, s51, 1
    s_cmp_eq_u32 s51, s52
    s_cselect_b32 s51, 0, s51
    buffer_load_dwordx4 v[12:15], v9, s[12:15], s48 offen sc1
    s_lshl_b32 s48, s51, 10
    s_add_u32 s48, s48, s55
    s_add_u32 s51, s51, 1
    s_cmp_eq_u32 s51, s52
    s_cselect_b32 s51, 0, s51
    buffer_load_dwordx4 v[16:19], v9, s[12:15], s48 offen sc1
    s_lshl_b32 s48, s51, 10
    s_add_u32 s48, s48, s55
    s_add_u32 s51, s51, 1
    s_cmp_eq_u32 s51, s52
    s_cselect_b32 s51, 0, s51
    buffer_load_dwordx4 v[20:23], v9, s[12:15], s48 offen sc1
    s_lshl_b32 s48, s51, 10
    s_add_u32 s48, s48, s55
    s_add_u32 s51, s51, 1
    s_cmp_eq_u32 s51, s52
    s_cselect_b32 s51, 0, s51
    buffer_load_dwordx4 v[24:27], v9, s[12:15], s48 offen sc1
    v_mov_b32 v2, 163076
    s_mov_b32 s42, 800000
G_free4h:
    ds_read_b32 v3, v2
    s_waitcnt lgkmcnt(0)
    v_readfirstlane_b32 s35, v3
    s_nop 0
    s_cmp_ge_u32 s35, 8
    s_cbranch_scc1 G_free4h_ok
    s_sleep 4
    s_sub_u32 s42, s42, 1
    s_cmp_lg_u32 s42, 0
    s_cbranch_scc1 G_free4h
G_free4h_ok:
    s_lshr_b32 s44, s33, 3
    s_add_u32 s44, s44, 4
    s_and_b32 s44, s44, 7
    s_mul_i32 s44, s44, 24576
    s_add_u32 s44, s44, s43
    s_add_u32 s44, s44, 10485760
    s_add_u32 m0, s43, 135168
    s_nop 0
    buffer_load_dwordx4 v9, s[12:15], s44 offen offset:0 sc1 lds
    buffer_load_dwordx4 v9, s[12:15], s44 offen offset:1024 sc1 lds
    buffer_load_dwordx4 v9, s[12:15], s44 offen offset:2048 sc1 lds
    buffer_load_dwordx4 v9, s[12:15], s44 offen offset:3072 sc1 lds
    s_add_u32 m0, m0, 4096
    s_add_u32 s44, s44, 4096
    buffer_load_dwordx4 v9, s[12:15], s44 offen offset:0 sc1 lds
    buffer_load_dwordx4 v9, s[12:15], s44 offen offset:1024 sc1 lds
    s_waitcnt vmcnt(18)
    s_setprio 0
    s_waitcnt lgkmcnt(8)
    v_mfma_f32_32x32x16_bf16 v[72:87], v[52:55], v[28:31], v[72:87]
    ds_read_b64_tr_b16 v[52:53], v10 offset:20480
    ds_read_b64_tr_b16 v[54:55], v10 offset:23040
    s_waitcnt lgkmcnt(8)
    v_mfma_f32_32x32x16_bf16 v[88:103], v[56:59], v[28:31], v[88:103]
    ds_read_b64_tr_b16 v[56:57], v10 offset:20544
    ds_read_b64_tr_b16 v[58:59], v10 offset:23104
    s_setprio 3
    s_waitcnt lgkmcnt(8)
    v_mfma_f32_32x32x16_bf16 v[104:119], v[60:63], v[28:31], v[104:119]
    ds_read_b64_tr_b16 v[60:61], v10 offset:20608
    ds_read_b64_tr_b16 v[62:63], v10 offset:23168
    s_setprio 0
    s_waitcnt lgkmcnt(8)
    v_mfma_f32_32x32x16_bf16 v[120:135], v[64:67], v[28:31], v[120:135]
    ds_read_b64_tr_b16 v[64:65], v10 offset:20672
    ds_read_b64_tr_b16 v[66:67], v10 offset:23232
    s_waitcnt lgkmcnt(8)
    v_mfma_f32_32x32x16_bf16 v[136:151], v[68:71], v[28:31], v[136:151]
    ds_read_b64_tr_b16 v[68:69], v10 offset:20736
    ds_read_b64_tr_b16 v[70:71], v10 offset:23296
    s_setprio 3
    s_waitcnt vmcnt(17)
    s_setprio 0
    s_waitcnt lgkmcnt(8)
    v_mfma_f32_32x32x16_bf16 v[72:87], v[52:55], v[32:35], v[72:87]
    ds_read_b64_tr_b16 v[52:53], v10 offset:35840
    ds_read_b64_tr_b16 v[54:55], v10 offset:38400
    s_waitcnt lgkmcnt(8)
    v_mfma_f32_32x32x16_bf16 v[88:103], v[56:59], v[32:35], v[88:103]
    ds_read_b64_tr_b16 v[56:57], v10 offset:35904
    ds_read_b64_tr_b16 v[58:59], v10 offset:38464
    s_setprio 3
    s_waitcnt lgkmcnt(8)
    v_mfma_f32_32x32x16_bf16 v[104:119], v[60:63], v[32:35], v[104:119]
    ds_read_b64_tr_b16 v[60:61], v10 offset:35968
    ds_read_b64_tr_b16 v[62:63], v10 offset:38528
    s_setprio 0
    s_waitcnt lgkmcnt(8)
    v_mfma_f32_32x32x16_bf16 v[120:135], v[64:67], v[32:35], v[120:135]
    ds_read_b64_tr_b16 v[64:65], v10 offset:36032
    ds_read_b64_tr_b16 v[66:67], v10 offset:38592
    s_waitcnt lgkmcnt(8)
    v_mfma_f32_32x32x16_bf16 v[136:151], v[68:71], v[32:35], v[136:151]
    ds_read_b64_tr_b16 v[68:69], v10 offset:36096
    ds_read_b64_tr_b16 v[70:71], v10 offset:38656
    s_setprio 3
    s_waitcnt vmcnt(0)
    s_mov_b64 exec, 1
    v_mov_b32 v2, 163340
    v_mov_b32 v3, 1
    ds_add_u32 v2, v3
    s_mov_b64 exec, -1
    s_setprio 0
    s_waitcnt lgkmcnt(9)
    v_mfma_f32_32x32x16_bf16 v[72:87], v[52:55], v[36:39], v[72:87]
    ds_read_b64_tr_b16 v[52:53], v10 offset:51200
    ds_read_b64_tr_b16 v[54:55], v10 offset:53760
    s_waitcnt lgkmcnt(9)
    v_mfma_f32_32x32x16_bf16 v[88:103], v[56:59], v[36:39], v[88:103]
    ds_read_b64_tr_b16 v[56:57], v10 offset:51264
    ds_read_b64_tr_b16 v[58:59], v10 offset:53824
    s_setprio 3
    s_waitcnt lgkmcnt(9)
    v_mfma_f32_32x32x16_bf16 v[104:119], v[60:63], v[36:39], v[104:119]
    ds_read_b64_tr_b16 v[60:61], v10 offset:51328
    ds_read_b64_tr_b16 v[62:63], v10 offset:53888
    s_setprio 0
    s_waitcnt lgkmcnt(9)
    v_mfma_f32_32x32x16_bf16 v[120:135], v[64:67], v[36:39], v[120:135]
    ds_read_b64_tr_b16 v[64:65], v10 offset:51392
    ds_read_b64_tr_b16 v[66:67], v10 offset:53952
    s_waitcnt lgkmcnt(9)
    v_mfma_f32_32x32x16_bf16 v[136:151], v[68:71], v[36:39], v[136:151]
    ds_read_b64_tr_b16 v[68:69], v10 offset:51456
    ds_read_b64_tr_b16 v[70:71], v10 offset:54016
    s_setprio 3
    s_mov_b64 exec, 1
    v_mov_b32 v2, 162856
    v_mov_b32 v3, 1
    ds_add_u32 v2, v3
    s_mov_b64 exec, -1
    v_mov_b32 v2, 162856
    s_mov_b32 s42, 800000
G_sync2h:
    ds_read_b32 v3, v2
    s_waitcnt lgkmcnt(0)
    v_readfirstlane_b32 s35, v3
    s_nop 0
    s_cmp_ge_u32 s35, 4
    s_cbranch_scc1 G_sync2h_ok
    s_sleep 1
    s_sub_u32 s42, s42, 1
    s_cmp_lg_u32 s42, 0
    s_cbranch_scc1 G_sync2h
G_sync2h_ok:
    s_cmp_ge_u32 s50, s52
    s_cselect_b32 s35, s52, 0
    s_sub_u32 s50, s50, s35
    s_mul_i32 s47, s50, 20480
    s_add_u32 s47, s47, s54
    s_add_u32 s50, s50, 4
    s_add_u32 m0, s46, 5120
    s_nop 0
    buffer_load_dwordx4 v4, s[8:11], s47 offen offset:0 lds
    buffer_load_dwordx4 v5, s[8:11], s47 offen offset:1024 lds
    buffer_load_dwordx4 v6, s[8:11], s47 offen offset:2048 lds
    buffer_load_dwordx4 v7, s[8:11], s47 offen offset:3072 lds
    s_add_u32 m0, m0, 4096
    s_nop 0
    buffer_load_dwordx4 v8, s[8:11], s47 offen lds
    s_setprio 0
    v_mfma_f32_32x32x16_bf16 v[72:87], v[52:55], v[40:43], v[72:87]
    ds_read_b64_tr_b16 v[52:53], v10 offset:10240
    ds_read_b64_tr_b16 v[54:55], v10 offset:12800
    v_mfma_f32_32x32x16_bf16 v[88:103], v[56:59], v[40:43], v[88:103]
    ds_read_b64_tr_b16 v[56:57], v10 offset:10304
    ds_read_b64_tr_b16 v[58:59], v10 offset:12864
    s_setprio 3
    v_mfma_f32_32x32x16_bf16 v[104:119], v[60:63], v[40:43], v[104:119]
    ds_read_b64_tr_b16 v[60:61], v10 offset:10368
    ds_read_b64_tr_b16 v[62:63], v10 offset:12928
    s_setprio 0
    v_mfma_f32_32x32x16_bf16 v[120:135], v[64:67], v[40:43], v[120:135]
    ds_read_b64_tr_b16 v[64:65], v10 offset:10432
    ds_read_b64_tr_b16 v[66:67], v10 offset:12992
    v_mfma_f32_32x32x16_bf16 v[136:151], v[68:71], v[40:43], v[136:151]
    ds_read_b64_tr_b16 v[68:69], v10 offset:10496
    ds_read_b64_tr_b16 v[70:71], v10 offset:13056
    s_setprio 3
    s_lshl_b32 s48, s51, 10
    s_add_u32 s48, s48, s55
    s_add_u32 s51, s51, 1
    s_cmp_eq_u32 s51, s52
    s_cselect_b32 s51, 0, s51
    buffer_load_dwordx4 v[28:31], v9, s[12:15], s48 offen sc1
    s_lshl_b32 s48, s51, 10
    s_add_u32 s48, s48, s55
    s_add_u32 s51, s51, 1
    s_cmp_eq_u32 s51, s52
    s_cselect_b32 s51, 0, s51
    buffer_load_dwordx4 v[32:35], v9, s[12:15], s48 offen sc1
    s_lshl_b32 s48, s51, 10
    s_add_u32 s48, s48, s55
    s_add_u32 s51, s51, 1
    s_cmp_eq_u32 s51, s52
    s_cselect_b32 s51, 0, s51
    buffer_load_dwordx4 v[36:39], v9, s[12:15], s48 offen sc1
    s_lshl_b32 s48, s51, 10
    s_add_u32 s48, s48, s55
    s_add_u32 s51, s51, 1
    s_cmp_eq_u32 s51, s52
    s_cselect_b32 s51, 0, s51
    buffer_load_dwordx4 v[40:43], v9, s[12:15], s48 offen sc1
    s_lshl_b32 s35, s64, 2
    s_add_u32 s35, s35, s32
    s_mul_i32 s35, s35, 2560
    s_add_u32 s35, s35, 11534336
    buffer_store_dwordx4 v[162:165], v9, s[12:15], s35 offen offset:0 sc1
    buffer_store_dwordx4 v[162:165], v9, s[12:15], s35 offen offset:1024 sc1
    buffer_store_dwordx4 v[162:165], v9, s[12:15], s35 offen offset:1536 sc1
    v_mov_b32 v2, 163080
    s_mov_b32 s42, 800000
G_free5h:
    ds_read_b32 v3, v2
    s_waitcnt lgkmcnt(0)
    v_readfirstlane_b32 s35, v3
    s_nop 0
    s_cmp_ge_u32 s35, 8
    s_cbranch_scc1 G_free5h_ok
    s_sleep 4
    s_sub_u32 s42, s42, 1
    s_cmp_lg_u32 s42, 0
    s_cbranch_scc1 G_free5h
G_free5h_ok:
    s_lshr_b32 s44, s33, 3
    s_add_u32 s44, s44, 5
    s_and_b32 s44, s44, 7
    s_mul_i32 s44, s44, 24576
    s_add_u32 s44, s44, s43
    s_add_u32 s44, s44, 10485760
    s_add_u32 m0, s43, 110592
    s_nop 0
    buffer_load_dwordx4 v9, s[12:15], s44 offen offset:0 sc1 lds
    buffer_load_dwordx4 v9, s[12:15], s44 offen offset:1024 sc1 lds
    buffer_load_dwordx4 v9, s[12:15], s44 offen offset:2048 sc1 lds
    buffer_load_dwordx4 v9, s[12:15], s44 offen offset:3072 sc1 lds
    s_add_u32 m0, m0, 4096
    s_add_u32 s44, s44, 4096
    buffer_load_dwordx4 v9, s[12:15], s44 offen offset:0 sc1 lds
    buffer_load_dwordx4 v9, s[12:15], s44 offen offset:1024 sc1 lds
    s_setprio 0
    s_waitcnt lgkmcnt(8)
    v_mfma_f32_32x32x16_bf16 v[72:87], v[52:55], v[12:15], v[72:87]
    ds_read_b64_tr_b16 v[52:53], v10 offset:25600
    ds_read_b64_tr_b16 v[54:55], v10 offset:28160
    s_waitcnt lgkmcnt(8)
    v_mfma_f32_32x32x16_bf16 v[88:103], v[56:59], v[12:15], v[88:103]
    ds_read_b64_tr_b16 v[56:57], v10 offset:25664
    ds_read_b64_tr_b16 v[58:59], v10 offset:28224
    s_setprio 3
    s_waitcnt lgkmcnt(8)
    v_mfma_f32_32x32x16_bf16 v[104:119], v[60:63], v[12:15], v[104:119]
    ds_read_b64_tr_b16 v[60:61], v10 offset:25728
    ds_read_b64_tr_b16 v[62:63], v10 offset:28288
    s_setprio 0
    s_waitcnt lgkmcnt(8)
    v_mfma_f32_32x32x16_bf16 v[120:135], v[64:67], v[12:15], v[120:135]
    ds_read_b64_tr_b16 v[64:65], v10 offset:25792
    ds_read_b64_tr_b16 v[66:67], v10 offset:28352
    s_waitcnt lgkmcnt(8)
    v_mfma_f32_32x32x16_bf16 v[136:151], v[68:71], v[12:15], v[136:151]
    ds_read_b64_tr_b16 v[68:69], v10 offset:25856
    ds_read_b64_tr_b16 v[70:71], v10 offset:28416
    s_setprio 3
    s_setprio 0
    s_waitcnt lgkmcnt(8)
    v_mfma_f32_32x32x16_bf16 v[72:87], v[52:55], v[16:19], v[72:87]
    ds_read_b64_tr_b16 v[52:53], v10 offset:40960
    ds_read_b64_tr_b16 v[54:55], v10 offset:43520
    s_waitcnt lgkmcnt(8)
    v_mfma_f32_32x32x16_bf16 v[88:103], v[56:59], v[16:19], v[88:103]
    ds_read_b64_tr_b16 v[56:57], v10 offset:41024
    ds_read_b64_tr_b16 v[58:59], v10 offset:43584
    s_setprio 3
    s_waitcnt lgkmcnt(8)
    v_mfma_f32_32x32x16_bf16 v[104:119], v[60:63], v[16:19], v[104:119]
    ds_read_b64_tr_b16 v[60:61], v10 offset:41088
    ds_read_b64_tr_b16 v[62:63], v10 offset:43648
    s_setprio 0
    s_waitcnt lgkmcnt(8)
    v_mfma_f32_32x32x16_bf16 v[120:135], v[64:67], v[16:19], v[120:135]
    ds_read_b64_tr_b16 v[64:65], v10 offset:41152
    ds_read_b64_tr_b16 v[66:67], v10 offset:43712
    s_waitcnt lgkmcnt(8)
    v_mfma_f32_32x32x16_bf16 v[136:151], v[68:71], v[16:19], v[136:151]
    ds_read_b64_tr_b16 v[68:69], v10 offset:41216
    ds_read_b64_tr_b16 v[70:71], v10 offset:43776
    s_setprio 3
    s_waitcnt vmcnt(0)
    s_mov_b64 exec, 1
    v_mov_b32 v2, 163344
    v_mov_b32 v3, 1
    ds_add_u32 v2, v3
    s_mov_b64 exec, -1
    s_setprio 0
    s_waitcnt lgkmcnt(9)
    v_mfma_f32_32x32x16_bf16 v[72:87], v[52:55], v[20:23], v[72:87]
    ds_read_b64_tr_b16 v[52:53], v10 offset:56320
    ds_read_b64_tr_b16 v[54:55], v10 offset:58880
    s_waitcnt lgkmcnt(9)
    v_mfma_f32_32x32x16_bf16 v[88:103], v[56:59], v[20:23], v[88:103]
    ds_read_b64_tr_b16 v[56:57], v10 offset:56384
    ds_read_b64_tr_b16 v[58:59], v10 offset:58944
    s_setprio 3
    s_waitcnt lgkmcnt(9)
    v_mfma_f32_32x32x16_bf16 v[104:119], v[60:63], v[20:23], v[104:119]
    ds_read_b64_tr_b16 v[60:61], v10 offset:56448
    ds_read_b64_tr_b16 v[62:63], v10 offset:59008
    s_setprio 0
    s_waitcnt lgkmcnt(9)
    v_mfma_f32_32x32x16_bf16 v[120:135], v[64:67], v[20:23], v[120:135]
    ds_read_b64_tr_b16 v[64:65], v10 offset:56512
    ds_read_b64_tr_b16 v[66:67], v10 offset:59072
    s_waitcnt lgkmcnt(9)
    v_mfma_f32_32x32x16_bf16 v[136:151], v[68:71], v[20:23], v[136:151]
    ds_read_b64_tr_b16 v[68:69], v10 offset:56576
    ds_read_b64_tr_b16 v[70:71], v10 offset:59136
    s_setprio 3
    s_mov_b64 exec, 1
    v_mov_b32 v2, 162860
    v_mov_b32 v3, 1
    ds_add_u32 v2, v3
    s_mov_b64 exec, -1
    v_mov_b32 v2, 162860
    s_mov_b32 s42, 800000
G_sync3h:
    ds_read_b32 v3, v2
    s_waitcnt lgkmcnt(0)
    v_readfirstlane_b32 s35, v3
    s_nop 0
    s_cmp_ge_u32 s35, 4
    s_cbranch_scc1 G_sync3h_ok
    s_sleep 1
    s_sub_u32 s42, s42, 1
    s_cmp_lg_u32 s42, 0
    s_cbranch_scc1 G_sync3h
G_sync3h_ok:
    s_cmp_ge_u32 s50, s52
    s_cselect_b32 s35, s52, 0
    s_sub_u32 s50, s50, s35
    s_mul_i32 s47, s50, 20480
    s_add_u32 s47, s47, s54
    s_add_u32 s50, s50, 4
    s_add_u32 m0, s46, 10240
    s_nop 0
    buffer_load_dwordx4 v4, s[8:11], s47 offen offset:0 lds
    buffer_load_dwordx4 v5, s[8:11], s47 offen offset:1024 lds
    buffer_load_dwordx4 v6, s[8:11], s47 offen offset:2048 lds
    buffer_load_dwordx4 v7, s[8:11], s47 offen offset:3072 lds
    s_add_u32 m0, m0, 4096
    s_nop 0
    buffer_load_dwordx4 v8, s[8:11], s47 offen lds
    s_setprio 0
    v_mfma_f32_32x32x16_bf16 v[72:87], v[52:55], v[24:27], v[72:87]
    ds_read_b64_tr_b16 v[52:53], v10 offset:0
    ds_read_b64_tr_b16 v[54:55], v10 offset:2560
    v_mfma_f32_32x32x16_bf16 v[88:103], v[56:59], v[24:27], v[88:103]
    ds_read_b64_tr_b16 v[56:57], v10 offset:64
    ds_read_b64_tr_b16 v[58:59], v10 offset:2624
    s_setprio 3
    v_mfma_f32_32x32x16_bf16 v[104:119], v[60:63], v[24:27], v[104:119]
    ds_read_b64_tr_b16 v[60:61], v10 offset:128
    ds_read_b64_tr_b16 v[62:63], v10 offset:2688
    s_setprio 0
    v_mfma_f32_32x32x16_bf16 v[120:135], v[64:67], v[24:27], v[120:135]
    ds_read_b64_tr_b16 v[64:65], v10 offset:192
    ds_read_b64_tr_b16 v[66:67], v10 offset:2752
    v_mfma_f32_32x32x16_bf16 v[136:151], v[68:71], v[24:27], v[136:151]
    ds_read_b64_tr_b16 v[68:69], v10 offset:256
    ds_read_b64_tr_b16 v[70:71], v10 offset:2816
    s_setprio 3
    s_lshl_b32 s48, s51, 10
    s_add_u32 s48, s48, s55
    s_add_u32 s51, s51, 1
    s_cmp_eq_u32 s51, s52
    s_cselect_b32 s51, 0, s51
    buffer_load_dwordx4 v[12:15], v9, s[12:15], s48 offen sc1
    s_lshl_b32 s48, s51, 10
    s_add_u32 s48, s48, s55
    s_add_u32 s51, s51, 1
    s_cmp_eq_u32 s51, s52
    s_cselect_b32 s51, 0, s51
    buffer_load_dwordx4 v[16:19], v9, s[12:15], s48 offen sc1
    s_lshl_b32 s48, s51, 10
    s_add_u32 s48, s48, s55
    s_add_u32 s51, s51, 1
    s_cmp_eq_u32 s51, s52
    s_cselect_b32 s51, 0, s51
    buffer_load_dwordx4 v[20:23], v9, s[12:15], s48 offen sc1
    s_lshl_b32 s48, s51, 10
    s_add_u32 s48, s48, s55
    s_add_u32 s51, s51, 1
    s_cmp_eq_u32 s51, s52
    s_cselect_b32 s51, 0, s51
    buffer_load_dwordx4 v[24:27], v9, s[12:15], s48 offen sc1
    s_bfe_u32 s35, s33, 0x30002
    s_mul_i32 s35, s35, 25600
    s_add_u32 s35, s35, s45
    s_add_u32 s36, s35, 12800
    buffer_load_dword v160, v158, s[16:19], s35 offen
    buffer_load_dword v161, v158, s[16:19], s36 offen
    s_setprio 0
    s_waitcnt lgkmcnt(8)
    v_mfma_f32_32x32x16_bf16 v[72:87], v[52:55], v[28:31], v[72:87]
    ds_read_b64_tr_b16 v[52:53], v10 offset:15360
    ds_read_b64_tr_b16 v[54:55], v10 offset:17920
    s_waitcnt lgkmcnt(8)
    v_mfma_f32_32x32x16_bf16 v[88:103], v[56:59], v[28:31], v[88:103]
    ds_read_b64_tr_b16 v[56:57], v10 offset:15424
    ds_read_b64_tr_b16 v[58:59], v10 offset:17984
    s_setprio 3
    s_waitcnt lgkmcnt(8)
    v_mfma_f32_32x32x16_bf16 v[104:119], v[60:63], v[28:31], v[104:119]
    ds_read_b64_tr_b16 v[60:61], v10 offset:15488
    ds_read_b64_tr_b16 v[62:63], v10 offset:18048
    s_setprio 0
    s_waitcnt lgkmcnt(8)
    v_mfma_f32_32x32x16_bf16 v[120:135], v[64:67], v[28:31], v[120:135]
    ds_read_b64_tr_b16 v[64:65], v10 offset:15552
    ds_read_b64_tr_b16 v[66:67], v10 offset:18112
    s_waitcnt lgkmcnt(8)
    v_mfma_f32_32x32x16_bf16 v[136:151], v[68:71], v[28:31], v[136:151]
    ds_read_b64_tr_b16 v[68:69], v10 offset:15616
    ds_read_b64_tr_b16 v[70:71], v10 offset:18176
    s_setprio 3
    s_setprio 0
    s_waitcnt lgkmcnt(8)
    v_mfma_f32_32x32x16_bf16 v[72:87], v[52:55], v[32:35], v[72:87]
    ds_read_b64_tr_b16 v[52:53], v10 offset:30720
    ds_read_b64_tr_b16 v[54:55], v10 offset:33280
    s_waitcnt lgkmcnt(8)
    v_mfma_f32_32x32x16_bf16 v[88:103], v[56:59], v[32:35], v[88:103]
    ds_read_b64_tr_b16 v[56:57], v10 offset:30784
    ds_read_b64_tr_b16 v[58:59], v10 offset:33344
    s_setprio 3
    s_waitcnt lgkmcnt(8)
    v_mfma_f32_32x32x16_bf16 v[104:119], v[60:63], v[32:35], v[104:119]
    ds_read_b64_tr_b16 v[60:61], v10 offset:30848
    ds_read_b64_tr_b16 v[62:63], v10 offset:33408
    s_setprio 0
    s_waitcnt lgkmcnt(8)
    v_mfma_f32_32x32x16_bf16 v[120:135], v[64:67], v[32:35], v[120:135]
    ds_read_b64_tr_b16 v[64:65], v10 offset:30912
    ds_read_b64_tr_b16 v[66:67], v10 offset:33472
    s_waitcnt lgkmcnt(8)
    v_mfma_f32_32x32x16_bf16 v[136:151], v[68:71], v[32:35], v[136:151]
    ds_read_b64_tr_b16 v[68:69], v10 offset:30976
    ds_read_b64_tr_b16 v[70:71], v10 offset:33536
    s_setprio 3
    s_setprio 0
    s_waitcnt lgkmcnt(8)
    v_mfma_f32_32x32x16_bf16 v[72:87], v[52:55], v[36:39], v[72:87]
    ds_read_b64_tr_b16 v[52:53], v10 offset:46080
    ds_read_b64_tr_b16 v[54:55], v10 offset:48640
    s_waitcnt lgkmcnt(8)
    v_mfma_f32_32x32x16_bf16 v[88:103], v[56:59], v[36:39], v[88:103]
    ds_read_b64_tr_b16 v[56:57], v10 offset:46144
    ds_read_b64_tr_b16 v[58:59], v10 offset:48704
    s_setprio 3
    s_waitcnt lgkmcnt(8)
    v_mfma_f32_32x32x16_bf16 v[104:119], v[60:63], v[36:39], v[104:119]
    ds_read_b64_tr_b16 v[60:61], v10 offset:46208
    ds_read_b64_tr_b16 v[62:63], v10 offset:48768
    s_setprio 0
    s_waitcnt lgkmcnt(8)
    v_mfma_f32_32x32x16_bf16 v[120:135], v[64:67], v[36:39], v[120:135]
    ds_read_b64_tr_b16 v[64:65], v10 offset:46272
    ds_read_b64_tr_b16 v[66:67], v10 offset:48832
    s_waitcnt lgkmcnt(8)
    v_mfma_f32_32x32x16_bf16 v[136:151], v[68:71], v[36:39], v[136:151]
    ds_read_b64_tr_b16 v[68:69], v10 offset:46336
    ds_read_b64_tr_b16 v[70:71], v10 offset:48896
    s_setprio 3
    s_mov_b64 exec, 1
    v_mov_b32 v2, 162864
    v_mov_b32 v3, 1
    ds_add_u32 v2, v3
    s_mov_b64 exec, -1
    v_mov_b32 v2, 162864
    s_mov_b32 s42, 800000
G_sync4h:
    ds_read_b32 v3, v2
    s_waitcnt lgkmcnt(0)
    v_readfirstlane_b32 s35, v3
    s_nop 0
    s_cmp_ge_u32 s35, 4
    s_cbranch_scc1 G_sync4h_ok
    s_sleep 1
    s_sub_u32 s42, s42, 1
    s_cmp_lg_u32 s42, 0
    s_cbranch_scc1 G_sync4h
G_sync4h_ok:
    s_cmp_ge_u32 s50, s52
    s_cselect_b32 s35, s52, 0
    s_sub_u32 s50, s50, s35
    s_mul_i32 s47, s50, 20480
    s_add_u32 s47, s47, s54
    s_add_u32 s50, s50, 4
    s_add_u32 m0, s46, 0
    s_nop 0
    buffer_load_dwordx4 v4, s[8:11], s47 offen offset:0 lds
    buffer_load_dwordx4 v5, s[8:11], s47 offen offset:1024 lds
    buffer_load_dwordx4 v6, s[8:11], s47 offen offset:2048 lds
    buffer_load_dwordx4 v7, s[8:11], s47 offen offset:3072 lds
    s_add_u32 m0, m0, 4096
    s_nop 0
    buffer_load_dwordx4 v8, s[8:11], s47 offen lds
    s_setprio 0
    v_mfma_f32_32x32x16_bf16 v[72:87], v[52:55], v[40:43], v[72:87]
    ds_read_b64_tr_b16 v[52:53], v10 offset:5120
    ds_read_b64_tr_b16 v[54:55], v10 offset:7680
    v_mfma_f32_32x32x16_bf16 v[88:103], v[56:59], v[40:43], v[88:103]
    ds_read_b64_tr_b16 v[56:57], v10 offset:5184
    ds_read_b64_tr_b16 v[58:59], v10 offset:7744
    s_setprio 3
    v_mfma_f32_32x32x16_bf16 v[104:119], v[60:63], v[40:43], v[104:119]
    ds_read_b64_tr_b16 v[60:61], v10 offset:5248
    ds_read_b64_tr_b16 v[62:63], v10 offset:7808
    s_setprio 0
    v_mfma_f32_32x32x16_bf16 v[120:135], v[64:67], v[40:43], v[120:135]
    ds_read_b64_tr_b16 v[64:65], v10 offset:5312
    ds_read_b64_tr_b16 v[66:67], v10 offset:7872
    v_mfma_f32_32x32x16_bf16 v[136:151], v[68:71], v[40:43], v[136:151]
    ds_read_b64_tr_b16 v[68:69], v10 offset:5376
    ds_read_b64_tr_b16 v[70:71], v10 offset:7936
    s_setprio 3
    s_lshl_b32 s48, s51, 10
    s_add_u32 s48, s48, s55
    s_add_u32 s51, s51, 1
    s_cmp_eq_u32 s51, s52
    s_cselect_b32 s51, 0, s51
    buffer_load_dwordx4 v[28:31], v9, s[12:15], s48 offen sc1
    s_lshl_b32 s48, s51, 10
    s_add_u32 s48, s48, s55
    s_add_u32 s51, s51, 1
    s_cmp_eq_u32 s51, s52
    s_cselect_b32 s51, 0, s51
    buffer_load_dwordx4 v[32:35], v9, s[12:15], s48 offen sc1
    s_lshl_b32 s48, s51, 10
    s_add_u32 s48, s48, s55
    s_add_u32 s51, s51, 1
    s_cmp_eq_u32 s51, s52
    s_cselect_b32 s51, 0, s51
    buffer_load_dwordx4 v[36:39], v9, s[12:15], s48 offen sc1
    s_lshl_b32 s48, s51, 10
    s_add_u32 s48, s48, s55
    s_add_u32 s51, s51, 1
    s_cmp_eq_u32 s51, s52
    s_cselect_b32 s51, 0, s51
    buffer_load_dwordx4 v[40:43], v9, s[12:15], s48 offen sc1
    s_waitcnt vmcnt(63)
    s_mov_b64 exec, 1
    v_mov_b32 v1, 162820
    v_mov_b32 v2, 1
    ds_add_rtn_u32 v2, v1, v2
    s_lshl_b32 s35, s64, 7
    s_add_u32 s35, s35, 19955712
    v_mov_b32 v1, s37
    v_mov_b32 v3, s39
    s_waitcnt lgkmcnt(0)
    v_readfirstlane_b32 s36, v2
    s_nop 0
    s_cmp_lg_u32 s36, 3
    s_cbranch_scc1 G_pubrh
    buffer_store_dword v3, v1, s[12:15], s35 offen sc1
G_pubrh:
    s_mov_b64 exec, -1
    v_mov_b32 v2, 163084
    s_mov_b32 s42, 800000
G_free6h:
    ds_read_b32 v3, v2
    s_waitcnt lgkmcnt(0)
    v_readfirstlane_b32 s35, v3
    s_nop 0
    s_cmp_ge_u32 s35, 8
    s_cbranch_scc1 G_free6h_ok
    s_sleep 4
    s_sub_u32 s42, s42, 1
    s_cmp_lg_u32 s42, 0
    s_cbranch_scc1 G_free6h
G_free6h_ok:
    s_lshr_b32 s44, s33, 3
    s_add_u32 s44, s44, 6
    s_and_b32 s44, s44, 7
    s_mul_i32 s44, s44, 24576
    s_add_u32 s44, s44, s43
    s_add_u32 s44, s44, 10485760
    s_add_u32 m0, s43, 86016
    s_nop 0
    buffer_load_dwordx4 v9, s[12:15], s44 offen offset:0 sc1 lds
    buffer_load_dwordx4 v9, s[12:15], s44 offen offset:1024 sc1 lds
    buffer_load_dwordx4 v9, s[12:15], s44 offen offset:2048 sc1 lds
    buffer_load_dwordx4 v9, s[12:15], s44 offen offset:3072 sc1 lds
    s_add_u32 m0, m0, 4096
    s_add_u32 s44, s44, 4096
    buffer_load_dwordx4 v9, s[12:15], s44 offen offset:0 sc1 lds
    buffer_load_dwordx4 v9, s[12:15], s44 offen offset:1024 sc1 lds
    s_waitcnt vmcnt(20)
    s_setprio 0
    v_mfma_f32_32x32x16_bf16 v[72:87], v[52:55], v[12:15], v[72:87]
    ds_read_b64_tr_b16 v[52:53], v10 offset:20480
    ds_read_b64_tr_b16 v[54:55], v10 offset:23040
    v_mfma_f32_32x32x16_bf16 v[88:103], v[56:59], v[12:15], v[88:103]
    ds_read_b64_tr_b16 v[56:57], v10 offset:20544
    ds_read_b64_tr_b16 v[58:59], v10 offset:23104
    s_setprio 3
    v_mfma_f32_32x32x16_bf16 v[104:119], v[60:63], v[12:15], v[104:119]
    ds_read_b64_tr_b16 v[60:61], v10 offset:20608
    ds_read_b64_tr_b16 v[62:63], v10 offset:23168
    s_setprio 0
    v_mfma_f32_32x32x16_bf16 v[120:135], v[64:67], v[12:15], v[120:135]
    ds_read_b64_tr_b16 v[64:65], v10 offset:20672
    ds_read_b64_tr_b16 v[66:67], v10 offset:23232
    v_mfma_f32_32x32x16_bf16 v[136:151], v[68:71], v[12:15], v[136:151]
    ds_read_b64_tr_b16 v[68:69], v10 offset:20736
    ds_read_b64_tr_b16 v[70:71], v10 offset:23296
    s_setprio 3
    s_waitcnt vmcnt(19)
    s_setprio 0
    s_waitcnt lgkmcnt(8)
    v_mfma_f32_32x32x16_bf16 v[72:87], v[52:55], v[16:19], v[72:87]
    ds_read_b64_tr_b16 v[52:53], v10 offset:35840
    ds_read_b64_tr_b16 v[54:55], v10 offset:38400
    s_waitcnt lgkmcnt(8)
    v_mfma_f32_32x32x16_bf16 v[88:103], v[56:59], v[16:19], v[88:103]
    ds_read_b64_tr_b16 v[56:57], v10 offset:35904
    ds_read_b64_tr_b16 v[58:59], v10 offset:38464
    s_setprio 3
    s_waitcnt lgkmcnt(8)
    v_mfma_f32_32x32x16_bf16 v[104:119], v[60:63], v[16:19], v[104:119]
    ds_read_b64_tr_b16 v[60:61], v10 offset:35968
    ds_read_b64_tr_b16 v[62:63], v10 offset:38528
    s_setprio 0
    s_waitcnt lgkmcnt(8)
    v_mfma_f32_32x32x16_bf16 v[120:135], v[64:67], v[16:19], v[120:135]
    ds_read_b64_tr_b16 v[64:65], v10 offset:36032
    ds_read_b64_tr_b16 v[66:67], v10 offset:38592
    s_waitcnt lgkmcnt(8)
    v_mfma_f32_32x32x16_bf16 v[136:151], v[68:71], v[16:19], v[136:151]
    ds_read_b64_tr_b16 v[68:69], v10 offset:36096
    ds_read_b64_tr_b16 v[70:71], v10 offset:38656
    s_setprio 3
    s_waitcnt vmcnt(0)
    s_mov_b64 exec, 1
    v_mov_b32 v2, 163348
    v_mov_b32 v3, 1
    ds_add_u32 v2, v3
    s_mov_b64 exec, -1
    s_setprio 0
    s_waitcnt lgkmcnt(9)
    v_mfma_f32_32x32x16_bf16 v[72:87], v[52:55], v[20:23], v[72:87]
    ds_read_b64_tr_b16 v[52:53], v10 offset:51200
    ds_read_b64_tr_b16 v[54:55], v10 offset:53760
    s_waitcnt lgkmcnt(9)
    v_mfma_f32_32x32x16_bf16 v[88:103], v[56:59], v[20:23], v[88:103]
    ds_read_b64_tr_b16 v[56:57], v10 offset:51264
    ds_read_b64_tr_b16 v[58:59], v10 offset:53824
    s_setprio 3
    s_waitcnt lgkmcnt(9)
    v_mfma_f32_32x32x16_bf16 v[104:119], v[60:63], v[20:23], v[104:119]
    ds_read_b64_tr_b16 v[60:61], v10 offset:51328
    ds_read_b64_tr_b16 v[62:63], v10 offset:53888
    s_setprio 0
    s_waitcnt lgkmcnt(9)
    v_mfma_f32_32x32x16_bf16 v[120:135], v[64:67], v[20:23], v[120:135]
    ds_read_b64_tr_b16 v[64:65], v10 offset:51392
    ds_read_b64_tr_b16 v[66:67], v10 offset:53952
    s_waitcnt lgkmcnt(9)
    v_mfma_f32_32x32x16_bf16 v[136:151], v[68:71], v[20:23], v[136:151]
    ds_read_b64_tr_b16 v[68:69], v10 offset:51456
    ds_read_b64_tr_b16 v[70:71], v10 offset:54016
    s_setprio 3
    s_mov_b64 exec, 1
    v_mov_b32 v2, 162868
    v_mov_b32 v3, 1
    ds_add_u32 v2, v3
    s_mov_b64 exec, -1
    v_mov_b32 v2, 162868
    s_mov_b32 s42, 800000
G_sync5h:
    ds_read_b32 v3, v2
    s_waitcnt lgkmcnt(0)
    v_readfirstlane_b32 s35, v3
    s_nop 0
    s_cmp_ge_u32 s35, 4
    s_cbranch_scc1 G_sync5h_ok
    s_sleep 1
    s_sub_u32 s42, s42, 1
    s_cmp_lg_u32 s42, 0
    s_cbranch_scc1 G_sync5h
G_sync5h_ok:
    s_add_u32 s47, s45, 25600
    s_add_u32 m0, s46, 5120
    s_nop 0
    buffer_load_dwordx4 v4, s[16:19], s47 offen offset:0 lds
    buffer_load_dwordx4 v5, s[16:19], s47 offen offset:1024 lds
    buffer_load_dwordx4 v6, s[16:19], s47 offen offset:2048 lds
    buffer_load_dwordx4 v7, s[16:19], s47 offen offset:3072 lds
    s_add_u32 m0, m0, 4096
    s_nop 0
    buffer_load_dwordx4 v8, s[16:19], s47 offen lds
    s_setprio 0
    v_mfma_f32_32x32x16_bf16 v[72:87], v[52:55], v[24:27], v[72:87]
    ds_read_b64_tr_b16 v[52:53], v10 offset:10240
    ds_read_b64_tr_b16 v[54:55], v10 offset:12800
    v_mfma_f32_32x32x16_bf16 v[88:103], v[56:59], v[24:27], v[88:103]
    ds_read_b64_tr_b16 v[56:57], v10 offset:10304
    ds_read_b64_tr_b16 v[58:59], v10 offset:12864
    s_setprio 3
    v_mfma_f32_32x32x16_bf16 v[104:119], v[60:63], v[24:27], v[104:119]
    ds_read_b64_tr_b16 v[60:61], v10 offset:10368
    ds_read_b64_tr_b16 v[62:63], v10 offset:12928
    s_setprio 0
    v_mfma_f32_32x32x16_bf16 v[120:135], v[64:67], v[24:27], v[120:135]
    ds_read_b64_tr_b16 v[64:65], v10 offset:10432
    ds_read_b64_tr_b16 v[66:67], v10 offset:12992
    v_mfma_f32_32x32x16_bf16 v[136:151], v[68:71], v[24:27], v[136:151]
    ds_read_b64_tr_b16 v[68:69], v10 offset:10496
    ds_read_b64_tr_b16 v[70:71], v10 offset:13056
    s_setprio 3
    s_lshl_b32 s48, s51, 10
    s_add_u32 s48, s48, s55
    s_add_u32 s51, s51, 1
    s_cmp_eq_u32 s51, s52
    s_cselect_b32 s51, 0, s51
    buffer_load_dwordx4 v[12:15], v9, s[12:15], s48 offen sc1
    s_lshl_b32 s48, s51, 10
    s_add_u32 s48, s48, s55
    s_add_u32 s51, s51, 1
    s_cmp_eq_u32 s51, s52
    s_cselect_b32 s51, 0, s51
    buffer_load_dwordx4 v[16:19], v9, s[12:15], s48 offen sc1
    s_lshl_b32 s48, s51, 10
    s_add_u32 s48, s48, s55
    s_add_u32 s51, s51, 1
    s_cmp_eq_u32 s51, s52
    s_cselect_b32 s51, 0, s51
    buffer_load_dwordx4 v[20:23], v9, s[12:15], s48 offen sc1
    v_add_u32 v2, 0, v157
    v_mul_u32_u24 v3, 0xcccd, v2
    v_lshrrev_b32 v3, 21, v3
    v_mul_u32_u24 v3, 960, v3
    v_lshl_add_u32 v1, v2, 3, v3
    buffer_load_dwordx2 v[158:159], v1, s[4:7], s41 offen
    v_add_u32 v2, 64, v157
    v_mul_u32_u24 v3, 0xcccd, v2
    v_lshrrev_b32 v3, 21, v3
    v_mul_u32_u24 v3, 960, v3
    v_lshl_add_u32 v1, v2, 3, v3
    buffer_load_dwordx2 v[160:161], v1, s[4:7], s41 offen
    v_add_u32 v2, 128, v157
    v_mul_u32_u24 v3, 0xcccd, v2
    v_lshrrev_b32 v3, 21, v3
    v_mul_u32_u24 v3, 960, v3
    v_lshl_add_u32 v1, v2, 3, v3
    buffer_load_dwordx2 v[162:163], v1, s[4:7], s41 offen
    v_add_u32 v2, 192, v157
    v_mul_u32_u24 v3, 0xcccd, v2
    v_lshrrev_b32 v3, 21, v3
    v_mul_u32_u24 v3, 960, v3
    v_lshl_add_u32 v1, v2, 3, v3
    buffer_load_dwordx2 v[164:165], v1, s[4:7], s41 offen
    v_add_u32 v2, 256, v157
    v_mul_u32_u24 v3, 0xcccd, v2
    v_lshrrev_b32 v3, 21, v3
    v_mul_u32_u24 v3, 960, v3
    v_lshl_add_u32 v1, v2, 3, v3
    buffer_load_dwordx2 v[166:167], v1, s[4:7], s41 offen
    s_setprio 0
    s_waitcnt lgkmcnt(8)
    v_mfma_f32_32x32x16_bf16 v[72:87], v[52:55], v[28:31], v[72:87]
    ds_read_b64_tr_b16 v[52:53], v10 offset:25600
    ds_read_b64_tr_b16 v[54:55], v10 offset:28160
    s_waitcnt lgkmcnt(8)
    v_mfma_f32_32x32x16_bf16 v[88:103], v[56:59], v[28:31], v[88:103]
    ds_read_b64_tr_b16 v[56:57], v10 offset:25664
    ds_read_b64_tr_b16 v[58:59], v10 offset:28224
    s_setprio 3
    s_waitcnt lgkmcnt(8)
    v_mfma_f32_32x32x16_bf16 v[104:119], v[60:63], v[28:31], v[104:119]
    ds_read_b64_tr_b16 v[60:61], v10 offset:25728
    ds_read_b64_tr_b16 v[62:63], v10 offset:28288
    s_setprio 0
    s_waitcnt lgkmcnt(8)
    v_mfma_f32_32x32x16_bf16 v[120:135], v[64:67], v[28:31], v[120:135]
    ds_read_b64_tr_b16 v[64:65], v10 offset:25792
    ds_read_b64_tr_b16 v[66:67], v10 offset:28352
    s_waitcnt lgkmcnt(8)
    v_mfma_f32_32x32x16_bf16 v[136:151], v[68:71], v[28:31], v[136:151]
    ds_read_b64_tr_b16 v[68:69], v10 offset:25856
    ds_read_b64_tr_b16 v[70:71], v10 offset:28416
    s_setprio 3
    s_setprio 0
    s_waitcnt lgkmcnt(8)
    v_mfma_f32_32x32x16_bf16 v[72:87], v[52:55], v[32:35], v[72:87]
    ds_read_b64_tr_b16 v[52:53], v10 offset:40960
    ds_read_b64_tr_b16 v[54:55], v10 offset:43520
    s_waitcnt lgkmcnt(8)
    v_mfma_f32_32x32x16_bf16 v[88:103], v[56:59], v[32:35], v[88:103]
    ds_read_b64_tr_b16 v[56:57], v10 offset:41024
    ds_read_b64_tr_b16 v[58:59], v10 offset:43584
    s_setprio 3
    s_waitcnt lgkmcnt(8)
    v_mfma_f32_32x32x16_bf16 v[104:119], v[60:63], v[32:35], v[104:119]
    ds_read_b64_tr_b16 v[60:61], v10 offset:41088
    ds_read_b64_tr_b16 v[62:63], v10 offset:43648
    s_setprio 0
    s_waitcnt lgkmcnt(8)
    v_mfma_f32_32x32x16_bf16 v[120:135], v[64:67], v[32:35], v[120:135]
    ds_read_b64_tr_b16 v[64:65], v10 offset:41152
    ds_read_b64_tr_b16 v[66:67], v10 offset:43712
    s_waitcnt lgkmcnt(8)
    v_mfma_f32_32x32x16_bf16 v[136:151], v[68:71], v[32:35], v[136:151]
    ds_read_b64_tr_b16 v[68:69], v10 offset:41216
    ds_read_b64_tr_b16 v[70:71], v10 offset:43776
    s_setprio 3
    s_setprio 0
    s_waitcnt lgkmcnt(8)
    v_mfma_f32_32x32x16_bf16 v[72:87], v[52:55], v[36:39], v[72:87]
    ds_read_b64_tr_b16 v[52:53], v10 offset:56320
    ds_read_b64_tr_b16 v[54:55], v10 offset:58880
    s_waitcnt lgkmcnt(8)
    v_mfma_f32_32x32x16_bf16 v[88:103], v[56:59], v[36:39], v[88:103]
    ds_read_b64_tr_b16 v[56:57], v10 offset:56384
    ds_read_b64_tr_b16 v[58:59], v10 offset:58944
    s_setprio 3
    s_waitcnt lgkmcnt(8)
    v_mfma_f32_32x32x16_bf16 v[104:119], v[60:63], v[36:39], v[104:119]
    ds_read_b64_tr_b16 v[60:61], v10 offset:56448
    ds_read_b64_tr_b16 v[62:63], v10 offset:59008
    s_setprio 0
    s_waitcnt lgkmcnt(8)
    v_mfma_f32_32x32x16_bf16 v[120:135], v[64:67], v[36:39], v[120:135]
    ds_read_b64_tr_b16 v[64:65], v10 offset:56512
    ds_read_b64_tr_b16 v[66:67], v10 offset:59072
    s_waitcnt lgkmcnt(8)
    v_mfma_f32_32x32x16_bf16 v[136:151], v[68:71], v[36:39], v[136:151]
    ds_read_b64_tr_b16 v[68:69], v10 offset:56576
    ds_read_b64_tr_b16 v[70:71], v10 offset:59136
    s_setprio 3
    s_mov_b64 exec, 1
    v_mov_b32 v2, 162872
    v_mov_b32 v3, 1
    ds_add_u32 v2, v3
    s_mov_b64 exec, -1
    v_mov_b32 v2, 162872
    s_mov_b32 s42, 800000
G_sync6h:
    ds_read_b32 v3, v2
    s_waitcnt lgkmcnt(0)
    v_readfirstlane_b32 s35, v3
    s_nop 0
    s_cmp_ge_u32 s35, 4
    s_cbranch_scc1 G_sync6h_ok
    s_sleep 1
    s_sub_u32 s42, s42, 1
    s_cmp_lg_u32 s42, 0
    s_cbranch_scc1 G_sync6h
G_sync6h_ok:
    s_add_u32 s47, s45, 51200
    s_add_u32 m0, s46, 10240
    s_nop 0
    buffer_load_dwordx4 v4, s[16:19], s47 offen offset:0 lds
    buffer_load_dwordx4 v5, s[16:19], s47 offen offset:1024 lds
    buffer_load_dwordx4 v6, s[16:19], s47 offen offset:2048 lds
    buffer_load_dwordx4 v7, s[16:19], s47 offen offset:3072 lds
    s_add_u32 m0, m0, 4096
    s_nop 0
    buffer_load_dwordx4 v8, s[16:19], s47 offen lds
    s_setprio 0
    v_mfma_f32_32x32x16_bf16 v[72:87], v[52:55], v[40:43], v[72:87]
    ds_read_b64_tr_b16 v[52:53], v10 offset:0
    ds_read_b64_tr_b16 v[54:55], v10 offset:2560
    v_mfma_f32_32x32x16_bf16 v[88:103], v[56:59], v[40:43], v[88:103]
    ds_read_b64_tr_b16 v[56:57], v10 offset:64
    ds_read_b64_tr_b16 v[58:59], v10 offset:2624
    s_setprio 3
    v_mfma_f32_32x32x16_bf16 v[104:119], v[60:63], v[40:43], v[104:119]
    ds_read_b64_tr_b16 v[60:61], v10 offset:128
    ds_read_b64_tr_b16 v[62:63], v10 offset:2688
    s_setprio 0
    v_mfma_f32_32x32x16_bf16 v[120:135], v[64:67], v[40:43], v[120:135]
    ds_read_b64_tr_b16 v[64:65], v10 offset:192
    ds_read_b64_tr_b16 v[66:67], v10 offset:2752
    v_mfma_f32_32x32x16_bf16 v[136:151], v[68:71], v[40:43], v[136:151]
    ds_read_b64_tr_b16 v[68:69], v10 offset:256
    ds_read_b64_tr_b16 v[70:71], v10 offset:2816
    s_setprio 3
    s_lshl_b32 s35, s33, 2
    s_add_u32 s35, s35, s32
    s_lshl_b32 s35, s35, 7
    s_add_u32 s35, s35, s37
    s_add_u32 s40, s35, 19955712
    buffer_load_dword v1, off, s[12:15], s40 sc1
    v_mov_b32 v2, 163088
    s_mov_b32 s42, 800000
G_free7h:
    ds_read_b32 v3, v2
    s_waitcnt lgkmcnt(0)
    v_readfirstlane_b32 s35, v3
    s_nop 0
    s_cmp_ge_u32 s35, 8
    s_cbranch_scc1 G_free7h_ok
    s_sleep 4
    s_sub_u32 s42, s42, 1
    s_cmp_lg_u32 s42, 0
    s_cbranch_scc1 G_free7h
G_free7h_ok:
    s_lshr_b32 s44, s33, 3
    s_add_u32 s44, s44, 7
    s_and_b32 s44, s44, 7
    s_mul_i32 s44, s44, 24576
    s_add_u32 s44, s44, s43
    s_add_u32 s44, s44, 10485760
    s_add_u32 m0, s43, 61440
    s_nop 0
    buffer_load_dwordx4 v9, s[12:15], s44 offen offset:0 sc1 lds
    buffer_load_dwordx4 v9, s[12:15], s44 offen offset:1024 sc1 lds
    buffer_load_dwordx4 v9, s[12:15], s44 offen offset:2048 sc1 lds
    buffer_load_dwordx4 v9, s[12:15], s44 offen offset:3072 sc1 lds
    s_add_u32 m0, m0, 4096
    s_add_u32 s44, s44, 4096
    buffer_load_dwordx4 v9, s[12:15], s44 offen offset:0 sc1 lds
    buffer_load_dwordx4 v9, s[12:15], s44 offen offset:1024 sc1 lds
    s_waitcnt vmcnt(19)
    s_setprio 0
    s_waitcnt lgkmcnt(8)
    v_mfma_f32_32x32x16_bf16 v[72:87], v[52:55], v[12:15], v[72:87]
    ds_read_b64_tr_b16 v[52:53], v10 offset:15360
    ds_read_b64_tr_b16 v[54:55], v10 offset:17920
    s_waitcnt lgkmcnt(8)
    v_mfma_f32_32x32x16_bf16 v[88:103], v[56:59], v[12:15], v[88:103]
    ds_read_b64_tr_b16 v[56:57], v10 offset:15424
    ds_read_b64_tr_b16 v[58:59], v10 offset:17984
    s_setprio 3
    s_waitcnt lgkmcnt(8)
    v_mfma_f32_32x32x16_bf16 v[104:119], v[60:63], v[12:15], v[104:119]
    ds_read_b64_tr_b16 v[60:61], v10 offset:15488
    ds_read_b64_tr_b16 v[62:63], v10 offset:18048
    s_setprio 0
    s_waitcnt lgkmcnt(8)
    v_mfma_f32_32x32x16_bf16 v[120:135], v[64:67], v[12:15], v[120:135]
    ds_read_b64_tr_b16 v[64:65], v10 offset:15552
    ds_read_b64_tr_b16 v[66:67], v10 offset:18112
    s_waitcnt lgkmcnt(8)
    v_mfma_f32_32x32x16_bf16 v[136:151], v[68:71], v[12:15], v[136:151]
    ds_read_b64_tr_b16 v[68:69], v10 offset:15616
    ds_read_b64_tr_b16 v[70:71], v10 offset:18176
    s_setprio 3
    s_waitcnt vmcnt(18)
    s_setprio 0
    s_waitcnt lgkmcnt(8)
    v_mfma_f32_32x32x16_bf16 v[72:87], v[52:55], v[16:19], v[72:87]
    ds_read_b64_tr_b16 v[52:53], v10 offset:30720
    ds_read_b64_tr_b16 v[54:55], v10 offset:33280
    s_waitcnt lgkmcnt(8)
    v_mfma_f32_32x32x16_bf16 v[88:103], v[56:59], v[16:19], v[88:103]
    ds_read_b64_tr_b16 v[56:57], v10 offset:30784
    ds_read_b64_tr_b16 v[58:59], v10 offset:33344
    s_setprio 3
    s_waitcnt lgkmcnt(8)
    v_mfma_f32_32x32x16_bf16 v[104:119], v[60:63], v[16:19], v[104:119]
    ds_read_b64_tr_b16 v[60:61], v10 offset:30848
    ds_read_b64_tr_b16 v[62:63], v10 offset:33408
    s_setprio 0
    s_waitcnt lgkmcnt(8)
    v_mfma_f32_32x32x16_bf16 v[120:135], v[64:67], v[16:19], v[120:135]
    ds_read_b64_tr_b16 v[64:65], v10 offset:30912
    ds_read_b64_tr_b16 v[66:67], v10 offset:33472
    s_waitcnt lgkmcnt(8)
    v_mfma_f32_32x32x16_bf16 v[136:151], v[68:71], v[16:19], v[136:151]
    ds_read_b64_tr_b16 v[68:69], v10 offset:30976
    ds_read_b64_tr_b16 v[70:71], v10 offset:33536
    s_setprio 3
    s_waitcnt vmcnt(0)
    s_mov_b64 exec, 1
    v_mov_b32 v2, 163352
    v_mov_b32 v3, 1
    ds_add_u32 v2, v3
    s_mov_b64 exec, -1
    s_setprio 0
    s_waitcnt lgkmcnt(9)
    v_mfma_f32_32x32x16_bf16 v[72:87], v[52:55], v[20:23], v[72:87]
    s_waitcnt lgkmcnt(7)
    v_mfma_f32_32x32x16_bf16 v[88:103], v[56:59], v[20:23], v[88:103]
    s_setprio 3
    s_waitcnt lgkmcnt(5)
    v_mfma_f32_32x32x16_bf16 v[104:119], v[60:63], v[20:23], v[104:119]
    s_setprio 0
    s_waitcnt lgkmcnt(3)
    v_mfma_f32_32x32x16_bf16 v[120:135], v[64:67], v[20:23], v[120:135]
    s_waitcnt lgkmcnt(1)
    v_mfma_f32_32x32x16_bf16 v[136:151], v[68:71], v[20:23], v[136:151]
    s_setprio 3
    v_mov_b32 v2, 163092
    s_mov_b32 s42, 800000
G_alt0h:
    ds_read_b32 v3, v2
    s_waitcnt lgkmcnt(0)
    v_readfirstlane_b32 s35, v3
    s_nop 0
    s_cmp_ge_u32 s35, 8
    s_cbranch_scc1 G_alt0h_ok
    s_sleep 2
    s_sub_u32 s42, s42, 1
    s_cmp_lg_u32 s42, 0
    s_cbranch_scc1 G_alt0h
G_alt0h_ok:
    s_add_u32 s47, s45, 20480
    s_mul_i32 s35, s32, 5120
    s_add_u32 m0, s35, 135168
    s_nop 0
    buffer_load_dwordx4 v152, s[16:19], s47 offen offset:0 lds
    buffer_load_dwordx4 v153, s[16:19], s47 offen offset:1024 lds
    buffer_load_dwordx4 v154, s[16:19], s47 offen offset:2048 lds
    buffer_load_dwordx4 v155, s[16:19], s47 offen offset:3072 lds
    s_add_u32 m0, m0, 4096
    s_nop 0
    buffer_load_dwordx4 v156, s[16:19], s47 offen lds
    v_cmp_gt_u32 vcc, 1, v1
    s_nop 0
    s_cmp_eq_u64 vcc, 0
    s_cbranch_scc1 G_pollm_ok
    s_mov_b32 s42, 20000
G_pollm:
    buffer_load_dword v1, off, s[12:15], s40 sc1
    s_waitcnt vmcnt(0)
    v_cmp_gt_u32 vcc, 1, v1
    s_nop 0
    s_cmp_eq_u64 vcc, 0
    s_cbranch_scc1 G_pollm_ok
    s_sleep 8
    s_sub_u32 s42, s42, 1
    s_cmp_lg_u32 s42, 0
    s_cbranch_scc1 G_pollm
G_pollm_ok:
    v_readfirstlane_b32 s35, v1
    s_nop 0
    s_cmp_lg_u32 s35, s39
    s_cbranch_scc1 G_novote
    s_mov_b64 exec, 1
    v_mov_b32 v2, 163108
    v_mov_b32 v3, 1
    ds_add_u32 v2, v3
    s_mov_b64 exec, -1
G_novote:
    s_mov_b64 exec, 1
    v_mov_b32 v2, 162912
    v_mov_b32 v3, 1
    ds_add_u32 v2, v3
    s_mov_b64 exec, -1
    s_lshl_b32 s35, s32, 2
    s_cmp_eq_u32 s35, s37
    s_cbranch_scc1 G_keep
    s_lshl_b32 s35, s64, 2
    s_add_u32 s35, s35, s32
    s_mul_i32 s35, s35, 10240
    s_add_u32 s35, s35, 20971520
    s_nop 7
    v_cvt_pk_bf16_f32 v12, v72, v73
    v_cvt_pk_bf16_f32 v13, v74, v75
    v_cvt_pk_bf16_f32 v14, v76, v77
    v_cvt_pk_bf16_f32 v15, v78, v79
    buffer_store_dwordx4 v[12:15], v9, s[12:15], s35 offen offset:0 sc1
    v_cvt_pk_bf16_f32 v16, v80, v81
    v_cvt_pk_bf16_f32 v17, v82, v83
    v_cvt_pk_bf16_f32 v18, v84, v85
    v_cvt_pk_bf16_f32 v19, v86, v87
    buffer_store_dwordx4 v[16:19], v9, s[12:15], s35 offen offset:1024 sc1
    v_cvt_pk_bf16_f32 v20, v88, v89
    v_cvt_pk_bf16_f32 v21, v90, v91
    v_cvt_pk_bf16_f32 v22, v92, v93
    v_cvt_pk_bf16_f32 v23, v94, v95
    buffer_store_dwordx4 v[20:23], v9, s[12:15], s35 offen offset:2048 sc1
    v_cvt_pk_bf16_f32 v24, v96, v97
    v_cvt_pk_bf16_f32 v25, v98, v99
    v_cvt_pk_bf16_f32 v26, v100, v101
    v_cvt_pk_bf16_f32 v27, v102, v103
    buffer_store_dwordx4 v[24:27], v9, s[12:15], s35 offen offset:3072 sc1
    v_cvt_pk_bf16_f32 v28, v104, v105
    v_cvt_pk_bf16_f32 v29, v106, v107
    v_cvt_pk_bf16_f32 v30, v108, v109
    v_cvt_pk_bf16_f32 v31, v110, v111
    s_add_u32 s35, s35, 4096
    buffer_store_dwordx4 v[28:31], v9, s[12:15], s35 offen offset:0 sc1
    v_cvt_pk_bf16_f32 v32, v112, v113
    v_cvt_pk_bf16_f32 v33, v114, v115
    v_cvt_pk_bf16_f32 v34, v116, v117
    v_cvt_pk_bf16_f32 v35, v118, v119
    buffer_store_dwordx4 v[32:35], v9, s[12:15], s35 offen offset:1024 sc1
    v_cvt_pk_bf16_f32 v36, v120, v121
    v_cvt_pk_bf16_f32 v37, v122, v123
    v_cvt_pk_bf16_f32 v38, v124, v125
    v_cvt_pk_bf16_f32 v39, v126, v127
    buffer_store_dwordx4 v[36:39], v9, s[12:15], s35 offen offset:2048 sc1
    v_cvt_pk_bf16_f32 v40, v128, v129
    v_cvt_pk_bf16_f32 v41, v130, v131
    v_cvt_pk_bf16_f32 v42, v132, v133
    v_cvt_pk_bf16_f32 v43, v134, v135
    buffer_store_dwordx4 v[40:43], v9, s[12:15], s35 offen offset:3072 sc1
    v_cvt_pk_bf16_f32 v44, v136, v137
    v_cvt_pk_bf16_f32 v45, v138, v139
    v_cvt_pk_bf16_f32 v46, v140, v141
    v_cvt_pk_bf16_f32 v47, v142, v143
    s_add_u32 s35, s35, 4096
    buffer_store_dwordx4 v[44:47], v9, s[12:15], s35 offen offset:0 sc1
    v_cvt_pk_bf16_f32 v48, v144, v145
    v_cvt_pk_bf16_f32 v49, v146, v147
    v_cvt_pk_bf16_f32 v50, v148, v149
    v_cvt_pk_bf16_f32 v51, v150, v151
    buffer_store_dwordx4 v[48:51], v9, s[12:15], s35 offen offset:1024 sc1
G_keep:
    v_mov_b32 v2, 162912
    s_mov_b32 s42, 800000
G_sync7:
    ds_read_b32 v3, v2
    s_waitcnt lgkmcnt(0)
    v_readfirstlane_b32 s35, v3
    s_nop 0
    s_cmp_ge_u32 s35, 4
    s_cbranch_scc1 G_sync7_ok
    s_sleep 1
    s_sub_u32 s42, s42, 1
    s_cmp_lg_u32 s42, 0
    s_cbranch_scc1 G_sync7
G_sync7_ok:
    v_add_u32 v10, s46, v10
    s_add_u32 s47, s45, 0
    s_add_u32 m0, s46, 0
    s_nop 0
    buffer_load_dwordx4 v4, s[16:19], s47 offen offset:0 lds
    buffer_load_dwordx4 v5, s[16:19], s47 offen offset:1024 lds
    buffer_load_dwordx4 v6, s[16:19], s47 offen offset:2048 lds
    buffer_load_dwordx4 v7, s[16:19], s47 offen offset:3072 lds
    s_add_u32 m0, m0, 4096
    s_nop 0
    buffer_load_dwordx4 v8, s[16:19], s47 offen lds
    s_lshl_b32 s35, s33, 2
    s_add_u32 s35, s35, s32
    s_mul_i32 s48, s35, 10240
    s_add_u32 s48, s48, 11534336
    s_add_u32 s55, s48, 5120
    s_lshl_b32 s38, s38, 2
    s_add_u32 s38, s38, s34
    s_lshl_b32 s36, s38, 7
    s_add_u32 s36, s36, s37
    s_add_u32 s44, s36, 19955712
    s_lshl_b32 s36, s32, 2
    s_cmp_eq_u32 s36, s37
    s_cbranch_scc1 G_keep2
    s_lshl_b32 s35, s64, 7
    s_add_u32 s35, s35, s36
    s_add_u32 s35, s35, 19955712
    v_mov_b32 v1, 1
    s_waitcnt vmcnt(5)
    s_mov_b64 exec, 1
    buffer_store_dword v1, off, s[12:15], s35 sc1
    s_mov_b64 exec, -1
G_keep2:
    s_waitcnt vmcnt(0)
    ds_read_b64_tr_b16 v[52:53], v10 offset:0
    ds_read_b64_tr_b16 v[54:55], v10 offset:2560
    ds_read_b64_tr_b16 v[56:57], v10 offset:64
    ds_read_b64_tr_b16 v[58:59], v10 offset:2624
    ds_read_b64_tr_b16 v[60:61], v10 offset:128
    ds_read_b64_tr_b16 v[62:63], v10 offset:2688
    ds_read_b64_tr_b16 v[64:65], v10 offset:192
    ds_read_b64_tr_b16 v[66:67], v10 offset:2752
    ds_read_b64_tr_b16 v[68:69], v10 offset:256
    ds_read_b64_tr_b16 v[70:71], v10 offset:2816
    s_waitcnt lgkmcnt(0)
    s_add_u32 s47, s45, 76800
    s_add_u32 m0, s46, 0
    s_nop 0
    buffer_load_dwordx4 v4, s[16:19], s47 offen offset:0 lds
    buffer_load_dwordx4 v5, s[16:19], s47 offen offset:1024 lds
    buffer_load_dwordx4 v6, s[16:19], s47 offen offset:2048 lds
    buffer_load_dwordx4 v7, s[16:19], s47 offen offset:3072 lds
    s_add_u32 m0, m0, 4096
    s_nop 0
    buffer_load_dwordx4 v8, s[16:19], s47 offen lds
    v_mov_b32 v2, 163096
    s_mov_b32 s42, 800000
G_alt1x:
    ds_read_b32 v3, v2
    s_waitcnt lgkmcnt(0)
    v_readfirstlane_b32 s35, v3
    s_nop 0
    s_cmp_ge_u32 s35, 8
    s_cbranch_scc1 G_alt1x_ok
    s_sleep 2
    s_sub_u32 s42, s42, 1
    s_cmp_lg_u32 s42, 0
    s_cbranch_scc1 G_alt1x
G_alt1x_ok:
    s_add_u32 s47, s45, 102400
    s_mul_i32 s35, s32, 5120
    s_add_u32 m0, s35, 110592
    s_nop 0
    buffer_load_dwordx4 v4, s[16:19], s47 offen offset:0 lds
    buffer_load_dwordx4 v5, s[16:19], s47 offen offset:1024 lds
    buffer_load_dwordx4 v6, s[16:19], s47 offen offset:2048 lds
    buffer_load_dwordx4 v7, s[16:19], s47 offen offset:3072 lds
    s_add_u32 m0, m0, 4096
    s_nop 0
    buffer_load_dwordx4 v8, s[16:19], s47 offen lds
    s_mov_b32 s40, 0xffff0000
    s_lshl_b32 s36, s32, 2
    s_cmp_eq_u32 s36, s37
    s_cbranch_scc1 G_keep3
    s_mov_b32 s42, 20000
G_pollr:
    buffer_load_dword v1, off, s[12:15], s44 sc1
    s_waitcnt vmcnt(0)
    v_cmp_gt_u32 vcc, 1, v1
    s_nop 0
    s_cmp_eq_u64 vcc, 0
    s_cbranch_scc1 G_pollr_ok
    s_sleep 2
    s_sub_u32 s42, s42, 1
    s_cmp_lg_u32 s42, 0
    s_cbranch_scc1 G_pollr
G_pollr_ok:
    s_mul_i32 s35, s38, 40960
    s_mul_i32 s36, s37, 2560
    s_add_u32 s35, s35, s36
    s_add_u32 s35, s35, 20971520
    buffer_load_dwordx4 v[12:15], v9, s[12:15], s35 offen offset:0 sc1
    buffer_load_dwordx4 v[16:19], v9, s[12:15], s35 offen offset:1024 sc1
    buffer_load_dwordx4 v[20:23], v9, s[12:15], s35 offen offset:2048 sc1
    buffer_load_dwordx4 v[24:27], v9, s[12:15], s35 offen offset:3072 sc1
    s_add_u32 s35, s35, 4096
    buffer_load_dwordx4 v[28:31], v9, s[12:15], s35 offen offset:0 sc1
    buffer_load_dwordx4 v[32:35], v9, s[12:15], s35 offen offset:1024 sc1
    buffer_load_dwordx4 v[36:39], v9, s[12:15], s35 offen offset:2048 sc1
    buffer_load_dwordx4 v[40:43], v9, s[12:15], s35 offen offset:3072 sc1
    s_add_u32 s35, s35, 4096
    buffer_load_dwordx4 v[44:47], v9, s[12:15], s35 offen offset:0 sc1
    buffer_load_dwordx4 v[48:51], v9, s[12:15], s35 offen offset:1024 sc1
    s_waitcnt vmcnt(5)
    v_lshlrev_b32 v72, 16, v12
    v_and_b32 v73, s40, v12
    v_lshlrev_b32 v74, 16, v13
    v_and_b32 v75, s40, v13
    v_lshlrev_b32 v76, 16, v14
    v_and_b32 v77, s40, v14
    v_lshlrev_b32 v78, 16, v15
    v_and_b32 v79, s40, v15
    v_lshlrev_b32 v80, 16, v16
    v_and_b32 v81, s40, v16
    v_lshlrev_b32 v82, 16, v17
    v_and_b32 v83, s40, v17
    v_lshlrev_b32 v84, 16, v18
    v_and_b32 v85, s40, v18
    v_lshlrev_b32 v86, 16, v19
    v_and_b32 v87, s40, v19
    v_lshlrev_b32 v88, 16, v20
    v_and_b32 v89, s40, v20
    v_lshlrev_b32 v90, 16, v21
    v_and_b32 v91, s40, v21
    v_lshlrev_b32 v92, 16, v22
    v_and_b32 v93, s40, v22
    v_lshlrev_b32 v94, 16, v23
    v_and_b32 v95, s40, v23
    v_lshlrev_b32 v96, 16, v24
    v_and_b32 v97, s40, v24
    v_lshlrev_b32 v98, 16, v25
    v_and_b32 v99, s40, v25
    v_lshlrev_b32 v100, 16, v26
    v_and_b32 v101, s40, v26
    v_lshlrev_b32 v102, 16, v27
    v_and_b32 v103, s40, v27
    v_lshlrev_b32 v104, 16, v28
    v_and_b32 v105, s40, v28
    v_lshlrev_b32 v106, 16, v29
    v_and_b32 v107, s40, v29
    v_lshlrev_b32 v108, 16, v30
    v_and_b32 v109, s40, v30
    v_lshlrev_b32 v110, 16, v31
    v_and_b32 v111, s40, v31
G_keep3:
    v_mov_b32 v2, 163104
    s_mov_b32 s42, 800000
G_trig0:
    ds_read_b32 v3, v2
    s_waitcnt lgkmcnt(0)
    v_readfirstlane_b32 s35, v3
    s_nop 0
    s_cmp_ge_u32 s35, 4
    s_cbranch_scc1 G_trig0_ok
    s_sleep 1
    s_sub_u32 s42, s42, 1
    s_cmp_lg_u32 s42, 0
    s_cbranch_scc1 G_trig0
G_trig0_ok:
    s_mov_b32 s42, 20000
    buffer_load_dwordx4 v[12:15], v9, s[12:15], s48 offen offset:0 sc1
    buffer_load_dwordx4 v[16:19], v9, s[12:15], s48 offen offset:1280 sc1
    buffer_load_dwordx4 v[20:23], v9, s[12:15], s48 offen offset:2560 sc1
    buffer_load_dwordx4 v[24:27], v9, s[12:15], s48 offen offset:3840 sc1
    buffer_load_dwordx2 v[28:29], v11, s[12:15], s48 offen offset:1024 sc1
    buffer_load_dwordx2 v[30:31], v11, s[12:15], s48 offen offset:3584 sc1
    s_lshl_b32 s36, s32, 2
    s_cmp_eq_u32 s36, s37
    s_cbranch_scc1 G_keep4
    s_waitcnt vmcnt(6)
    v_lshlrev_b32 v112, 16, v32
    v_and_b32 v113, s40, v32
    v_lshlrev_b32 v114, 16, v33
    v_and_b32 v115, s40, v33
    v_lshlrev_b32 v116, 16, v34
    v_and_b32 v117, s40, v34
    v_lshlrev_b32 v118, 16, v35
    v_and_b32 v119, s40, v35
    v_lshlrev_b32 v120, 16, v36
    v_and_b32 v121, s40, v36
    v_lshlrev_b32 v122, 16, v37
    v_and_b32 v123, s40, v37
    v_lshlrev_b32 v124, 16, v38
    v_and_b32 v125, s40, v38
    v_lshlrev_b32 v126, 16, v39
    v_and_b32 v127, s40, v39
    v_lshlrev_b32 v128, 16, v40
    v_and_b32 v129, s40, v40
    v_lshlrev_b32 v130, 16, v41
    v_and_b32 v131, s40, v41
    v_lshlrev_b32 v132, 16, v42
    v_and_b32 v133, s40, v42
    v_lshlrev_b32 v134, 16, v43
    v_and_b32 v135, s40, v43
    v_lshlrev_b32 v136, 16, v44
    v_and_b32 v137, s40, v44
    v_lshlrev_b32 v138, 16, v45
    v_and_b32 v139, s40, v45
    v_lshlrev_b32 v140, 16, v46
    v_and_b32 v141, s40, v46
    v_lshlrev_b32 v142, 16, v47
    v_and_b32 v143, s40, v47
    v_lshlrev_b32 v144, 16, v48
    v_and_b32 v145, s40, v48
    v_lshlrev_b32 v146, 16, v49
    v_and_b32 v147, s40, v49
    v_lshlrev_b32 v148, 16, v50
    v_and_b32 v149, s40, v50
    v_lshlrev_b32 v150, 16, v51
    v_and_b32 v151, s40, v51
G_keep4:
    s_branch G_pollo0_chk
G_pollo0:
    buffer_load_dwordx4 v[12:15], v9, s[12:15], s48 offen offset:0 sc1
    buffer_load_dwordx4 v[16:19], v9, s[12:15], s48 offen offset:1280 sc1
    buffer_load_dwordx4 v[20:23], v9, s[12:15], s48 offen offset:2560 sc1
    buffer_load_dwordx4 v[24:27], v9, s[12:15], s48 offen offset:3840 sc1
    buffer_load_dwordx2 v[28:29], v11, s[12:15], s48 offen offset:1024 sc1
    buffer_load_dwordx2 v[30:31], v11, s[12:15], s48 offen offset:3584 sc1
G_pollo0_chk:
    s_waitcnt vmcnt(0)
    v_max3_u32 v1, v12, v13, v14
    v_max3_u32 v2, v15, v16, v17
    v_max3_u32 v3, v18, v19, v20
    v_max3_u32 v1, v1, v21, v22
    v_max3_u32 v2, v2, v23, v24
    v_max3_u32 v3, v3, v25, v26
    v_max3_u32 v1, v1, v27, v28
    v_max3_u32 v2, v2, v29, v30
    v_max_u32 v3, v3, v31
    v_max3_u32 v1, v1, v2, v3
    v_cmp_eq_u32 vcc, -1, v1
    s_nop 0
    s_cmp_eq_u64 vcc, 0
    s_cbranch_scc1 G_pollo0_ok
    s_sleep 1
    s_sub_u32 s42, s42, 1
    s_cmp_lg_u32 s42, 0
    s_cbranch_scc1 G_pollo0
G_pollo0_ok:
    v_mov_b32 v2, 163100
    s_mov_b32 s42, 800000
G_alt1:
    ds_read_b32 v3, v2
    s_waitcnt lgkmcnt(0)
    v_readfirstlane_b32 s35, v3
    s_nop 0
    s_cmp_ge_u32 s35, 8
    s_cbranch_scc1 G_alt1_ok
    s_sleep 1
    s_sub_u32 s42, s42, 1
    s_cmp_lg_u32 s42, 0
    s_cbranch_scc1 G_alt1
G_alt1_ok:
    s_add_u32 s47, s45, 128000
    s_mul_i32 s35, s32, 5120
    s_add_u32 m0, s35, 86016
    s_nop 0
    buffer_load_dwordx4 v4, s[16:19], s47 offen offset:0 lds
    buffer_load_dwordx4 v5, s[16:19], s47 offen offset:1024 lds
    buffer_load_dwordx4 v6, s[16:19], s47 offen offset:2048 lds
    buffer_load_dwordx4 v7, s[16:19], s47 offen offset:3072 lds
    s_add_u32 m0, m0, 4096
    s_nop 0
    buffer_load_dwordx4 v8, s[16:19], s47 offen lds
    s_setprio 0
    v_mfma_f32_32x32x16_bf16 v[72:87], v[52:55], v[12:15], v[72:87]
    ds_read_b64_tr_b16 v[52:53], v10 offset:5120
    ds_read_b64_tr_b16 v[54:55], v10 offset:7680
    v_mfma_f32_32x32x16_bf16 v[88:103], v[56:59], v[12:15], v[88:103]
    ds_read_b64_tr_b16 v[56:57], v10 offset:5184
    ds_read_b64_tr_b16 v[58:59], v10 offset:7744
    v_mfma_f32_32x32x16_bf16 v[104:119], v[60:63], v[12:15], v[104:119]
    ds_read_b64_tr_b16 v[60:61], v10 offset:5248
    ds_read_b64_tr_b16 v[62:63], v10 offset:7808
    v_mfma_f32_32x32x16_bf16 v[120:135], v[64:67], v[12:15], v[120:135]
    ds_read_b64_tr_b16 v[64:65], v10 offset:5312
    ds_read_b64_tr_b16 v[66:67], v10 offset:7872
    v_mfma_f32_32x32x16_bf16 v[136:151], v[68:71], v[12:15], v[136:151]
    ds_read_b64_tr_b16 v[68:69], v10 offset:5376
    ds_read_b64_tr_b16 v[70:71], v10 offset:7936
    s_setprio 3
    s_setprio 0
    s_waitcnt lgkmcnt(8)
    v_mfma_f32_32x32x16_bf16 v[72:87], v[52:55], v[16:19], v[72:87]
    ds_read_b64_tr_b16 v[52:53], v10 offset:10240
    ds_read_b64_tr_b16 v[54:55], v10 offset:12800
    s_waitcnt lgkmcnt(8)
    v_mfma_f32_32x32x16_bf16 v[88:103], v[56:59], v[16:19], v[88:103]
    ds_read_b64_tr_b16 v[56:57], v10 offset:10304
    ds_read_b64_tr_b16 v[58:59], v10 offset:12864
    s_waitcnt lgkmcnt(8)
    v_mfma_f32_32x32x16_bf16 v[104:119], v[60:63], v[16:19], v[104:119]
    ds_read_b64_tr_b16 v[60:61], v10 offset:10368
    ds_read_b64_tr_b16 v[62:63], v10 offset:12928
    s_waitcnt lgkmcnt(8)
    v_mfma_f32_32x32x16_bf16 v[120:135], v[64:67], v[16:19], v[120:135]
    ds_read_b64_tr_b16 v[64:65], v10 offset:10432
    ds_read_b64_tr_b16 v[66:67], v10 offset:12992
    s_waitcnt lgkmcnt(8)
    v_mfma_f32_32x32x16_bf16 v[136:151], v[68:71], v[16:19], v[136:151]
    ds_read_b64_tr_b16 v[68:69], v10 offset:10496
    ds_read_b64_tr_b16 v[70:71], v10 offset:13056
    s_setprio 3
    s_add_u32 s47, s45, 153600
    s_add_u32 m0, s46, 5120
    s_nop 0
    buffer_load_dwordx4 v4, s[16:19], s47 offen offset:0 lds
    buffer_load_dwordx4 v5, s[16:19], s47 offen offset:1024 lds
    buffer_load_dwordx4 v6, s[16:19], s47 offen offset:2048 lds
    buffer_load_dwordx4 v7, s[16:19], s47 offen offset:3072 lds
    s_add_u32 m0, m0, 4096
    s_nop 0
    buffer_load_dwordx4 v8, s[16:19], s47 offen lds
    s_setprio 0
    s_waitcnt lgkmcnt(8)
    v_mfma_f32_32x32x16_bf16 v[72:87], v[52:55], v[20:23], v[72:87]
    ds_read_b64_tr_b16 v[52:53], v10 offset:0
    ds_read_b64_tr_b16 v[54:55], v10 offset:2560
    s_waitcnt lgkmcnt(8)
    v_mfma_f32_32x32x16_bf16 v[88:103], v[56:59], v[20:23], v[88:103]
    ds_read_b64_tr_b16 v[56:57], v10 offset:64
    ds_read_b64_tr_b16 v[58:59], v10 offset:2624
    s_waitcnt lgkmcnt(8)
    v_mfma_f32_32x32x16_bf16 v[104:119], v[60:63], v[20:23], v[104:119]
    ds_read_b64_tr_b16 v[60:61], v10 offset:128
    ds_read_b64_tr_b16 v[62:63], v10 offset:2688
    s_waitcnt lgkmcnt(8)
    v_mfma_f32_32x32x16_bf16 v[120:135], v[64:67], v[20:23], v[120:135]
    ds_read_b64_tr_b16 v[64:65], v10 offset:192
    ds_read_b64_tr_b16 v[66:67], v10 offset:2752
    s_waitcnt lgkmcnt(8)
    v_mfma_f32_32x32x16_bf16 v[136:151], v[68:71], v[20:23], v[136:151]
    ds_read_b64_tr_b16 v[68:69], v10 offset:256
    ds_read_b64_tr_b16 v[70:71], v10 offset:2816
    s_setprio 3
    s_add_u32 s47, s45, 179200
    s_add_u32 m0, s46, 10240
    s_nop 0
    buffer_load_dwordx4 v4, s[16:19], s47 offen offset:0 lds
    buffer_load_dwordx4 v5, s[16:19], s47 offen offset:1024 lds
    buffer_load_dwordx4 v6, s[16:19], s47 offen offset:2048 lds
    buffer_load_dwordx4 v7, s[16:19], s47 offen offset:3072 lds
    s_add_u32 m0, m0, 4096
    s_nop 0
    buffer_load_dwordx4 v8, s[16:19], s47 offen lds
    s_setprio 0
    s_waitcnt lgkmcnt(8)
    v_mfma_f32_32x32x16_bf16 v[72:87], v[52:55], v[24:27], v[72:87]
    ds_read_b64_tr_b16 v[52:53], v0 offset:49152
    ds_read_b64_tr_b16 v[54:55], v0 offset:51712
    s_waitcnt lgkmcnt(8)
    v_mfma_f32_32x32x16_bf16 v[88:103], v[56:59], v[24:27], v[88:103]
    ds_read_b64_tr_b16 v[56:57], v0 offset:49216
    ds_read_b64_tr_b16 v[58:59], v0 offset:51776
    s_waitcnt lgkmcnt(8)
    v_mfma_f32_32x32x16_bf16 v[104:119], v[60:63], v[24:27], v[104:119]
    ds_read_b64_tr_b16 v[60:61], v0 offset:49280
    ds_read_b64_tr_b16 v[62:63], v0 offset:51840
    s_waitcnt lgkmcnt(8)
    v_mfma_f32_32x32x16_bf16 v[120:135], v[64:67], v[24:27], v[120:135]
    ds_read_b64_tr_b16 v[64:65], v0 offset:49344
    ds_read_b64_tr_b16 v[66:67], v0 offset:51904
    s_waitcnt lgkmcnt(8)
    v_mfma_f32_32x32x16_bf16 v[136:151], v[68:71], v[24:27], v[136:151]
    ds_read_b64_tr_b16 v[68:69], v0 offset:49408
    ds_read_b64_tr_b16 v[70:71], v0 offset:51968
    s_setprio 3
    s_add_u32 s47, s45, 122880
    s_add_u32 m0, s46, 0
    s_nop 0
    buffer_load_dwordx4 v152, s[16:19], s47 offen offset:0 lds
    buffer_load_dwordx4 v153, s[16:19], s47 offen offset:1024 lds
    buffer_load_dwordx4 v154, s[16:19], s47 offen offset:2048 lds
    buffer_load_dwordx4 v155, s[16:19], s47 offen offset:3072 lds
    s_add_u32 m0, m0, 4096
    s_nop 0
    buffer_load_dwordx4 v156, s[16:19], s47 offen lds
    s_mov_b32 s42, 20000
    buffer_load_dwordx4 v[32:35], v9, s[12:15], s55 offen offset:0 sc1
    buffer_load_dwordx4 v[36:39], v9, s[12:15], s55 offen offset:1280 sc1
    buffer_load_dwordx4 v[40:43], v9, s[12:15], s55 offen offset:2560 sc1
    buffer_load_dwordx4 v[44:47], v9, s[12:15], s55 offen offset:3840 sc1
    buffer_load_dwordx2 v[48:49], v11, s[12:15], s55 offen offset:1024 sc1
    buffer_load_dwordx2 v[50:51], v11, s[12:15], s55 offen offset:3584 sc1
    s_setprio 0
    s_waitcnt lgkmcnt(8)
    v_mfma_f32_32x32x16_bf16 v[72:87], v[52:55], v[28:31], v[72:87]
    ds_read_b64_tr_b16 v[52:53], v0 offset:24576
    ds_read_b64_tr_b16 v[54:55], v0 offset:27136
    s_waitcnt lgkmcnt(8)
    v_mfma_f32_32x32x16_bf16 v[88:103], v[56:59], v[28:31], v[88:103]
    ds_read_b64_tr_b16 v[56:57], v0 offset:24640
    ds_read_b64_tr_b16 v[58:59], v0 offset:27200
    s_waitcnt lgkmcnt(8)
    v_mfma_f32_32x32x16_bf16 v[104:119], v[60:63], v[28:31], v[104:119]
    ds_read_b64_tr_b16 v[60:61], v0 offset:24704
    ds_read_b64_tr_b16 v[62:63], v0 offset:27264
    s_waitcnt lgkmcnt(8)
    v_mfma_f32_32x32x16_bf16 v[120:135], v[64:67], v[28:31], v[120:135]
    ds_read_b64_tr_b16 v[64:65], v0 offset:24768
    ds_read_b64_tr_b16 v[66:67], v0 offset:27328
    s_waitcnt lgkmcnt(8)
    v_mfma_f32_32x32x16_bf16 v[136:151], v[68:71], v[28:31], v[136:151]
    ds_read_b64_tr_b16 v[68:69], v0 offset:24832
    ds_read_b64_tr_b16 v[70:71], v0 offset:27392
    s_setprio 3
    v_lshlrev_b32 v12, 16, v158
    v_and_b32 v13, s40, v158
    v_lshlrev_b32 v14, 16, v159
    v_and_b32 v15, s40, v159
    v_lshlrev_b32 v16, 16, v160
    v_and_b32 v17, s40, v160
    v_lshlrev_b32 v18, 16, v161
    v_and_b32 v19, s40, v161
    v_lshlrev_b32 v20, 16, v162
    v_and_b32 v21, s40, v162
    v_lshlrev_b32 v22, 16, v163
    v_and_b32 v23, s40, v163
    v_lshlrev_b32 v24, 16, v164
    v_and_b32 v25, s40, v164
    v_lshlrev_b32 v26, 16, v165
    v_and_b32 v27, s40, v165
    v_lshlrev_b32 v28, 16, v166
    v_and_b32 v29, s40, v166
    v_lshlrev_b32 v30, 16, v167
    v_and_b32 v31, s40, v167
    v_add_u32 v2, 0, v157
    v_mul_u32_u24 v3, 0xcccd, v2
    v_lshrrev_b32 v3, 21, v3
    v_xor_b32 v152, v2, v3
    v_lshlrev_b32 v152, 4, v152
    v_mul_u32_u24 v3, 960, v3
    v_lshl_add_u32 v4, v2, 3, v3
    v_add_u32 v2, 64, v157
    v_mul_u32_u24 v3, 0xcccd, v2
    v_lshrrev_b32 v3, 21, v3
    v_xor_b32 v153, v2, v3
    v_lshlrev_b32 v153, 4, v153
    v_mul_u32_u24 v3, 960, v3
    v_lshl_add_u32 v5, v2, 3, v3
    v_add_u32 v2, 128, v157
    v_mul_u32_u24 v3, 0xcccd, v2
    v_lshrrev_b32 v3, 21, v3
    v_xor_b32 v154, v2, v3
    v_lshlrev_b32 v154, 4, v154
    v_mul_u32_u24 v3, 960, v3
    v_lshl_add_u32 v6, v2, 3, v3
    v_add_u32 v2, 192, v157
    v_mul_u32_u24 v3, 0xcccd, v2
    v_lshrrev_b32 v3, 21, v3
    v_xor_b32 v155, v2, v3
    v_lshlrev_b32 v155, 4, v155
    v_mul_u32_u24 v3, 960, v3
    v_lshl_add_u32 v7, v2, 3, v3
    v_add_u32 v2, 256, v157
    v_mul_u32_u24 v3, 0xcccd, v2
    v_lshrrev_b32 v3, 21, v3
    v_xor_b32 v156, v2, v3
    v_lshlrev_b32 v156, 4, v156
    v_mul_u32_u24 v3, 960, v3
    v_lshl_add_u32 v8, v2, 3, v3
    s_mul_i32 s35, s32, 5120
    s_add_u32 s36, s35, 119808
    v_and_b32 v2, 31, v157
    v_mov_b32 v3, s46
    v_mov_b32 v1, s36
    v_cmp_lt_u32 vcc, 23, v2
    s_nop 1
    v_cndmask_b32 v3, v3, v1, vcc
    v_mul_u32_u24 v2, 640, v2
    v_add_u32 v3, v3, v2
    v_lshrrev_b32 v2, 5, v157
    v_and_b32 v1, 7, v157
    v_xor_b32 v2, v2, v1
    v_xor_b32 v1, 0, v2
    v_lshl_add_u32 v158, v1, 4, v3
    v_xor_b32 v1, 2, v2
    v_lshl_add_u32 v159, v1, 4, v3
    v_xor_b32 v1, 4, v2
    v_lshl_add_u32 v160, v1, 4, v3
    v_xor_b32 v1, 6, v2
    v_lshl_add_u32 v161, v1, 4, v3
    s_cmp_eq_u32 s32, 3
    s_cselect_b32 s24, 135168, s35
    s_movk_i32 s36, 15360
    s_cselect_b32 s36, 5120, s36
    s_add_u32 s25, s24, s36
    s_add_u32 s26, s25, s36
    s_add_u32 s27, s26, s36
    s_branch G_pollo1_chk
G_pollo1:
    buffer_load_dwordx4 v[32:35], v9, s[12:15], s55 offen offset:0 sc1
    buffer_load_dwordx4 v[36:39], v9, s[12:15], s55 offen offset:1280 sc1
    buffer_load_dwordx4 v[40:43], v9, s[12:15], s55 offen offset:2560 sc1
    buffer_load_dwordx4 v[44:47], v9, s[12:15], s55 offen offset:3840 sc1
    buffer_load_dwordx2 v[48:49], v11, s[12:15], s55 offen offset:1024 sc1
    buffer_load_dwordx2 v[50:51], v11, s[12:15], s55 offen offset:3584 sc1
G_pollo1_chk:
    s_waitcnt vmcnt(0)
    v_max3_u32 v1, v32, v33, v34
    v_max3_u32 v2, v35, v36, v37
    v_max3_u32 v3, v38, v39, v40
    v_max3_u32 v1, v1, v41, v42
    v_max3_u32 v2, v2, v43, v44
    v_max3_u32 v3, v3, v45, v46
    v_max3_u32 v1, v1, v47, v48
    v_max3_u32 v2, v2, v49, v50
    v_max_u32 v3, v3, v51
    v_max3_u32 v1, v1, v2, v3
    v_cmp_eq_u32 vcc, -1, v1
    s_nop 0
    s_cmp_eq_u64 vcc, 0
    s_cbranch_scc1 G_pollo1_ok
    s_sleep 1
    s_sub_u32 s42, s42, 1
    s_cmp_lg_u32 s42, 0
    s_cbranch_scc1 G_pollo1
G_pollo1_ok:
    s_setprio 3
    s_waitcnt lgkmcnt(8)
    v_mfma_f32_32x32x16_bf16 v[72:87], v[52:55], v[32:35], v[72:87]
    ds_read_b64_tr_b16 v[52:53], v0 offset:0
    ds_read_b64_tr_b16 v[54:55], v0 offset:2560
    s_waitcnt lgkmcnt(8)
    v_mfma_f32_32x32x16_bf16 v[88:103], v[56:59], v[32:35], v[88:103]
    ds_read_b64_tr_b16 v[56:57], v0 offset:64
    ds_read_b64_tr_b16 v[58:59], v0 offset:2624
    s_waitcnt lgkmcnt(8)
    v_mfma_f32_32x32x16_bf16 v[104:119], v[60:63], v[32:35], v[104:119]
    ds_read_b64_tr_b16 v[60:61], v0 offset:128
    ds_read_b64_tr_b16 v[62:63], v0 offset:2688
    s_waitcnt lgkmcnt(8)
    v_mfma_f32_32x32x16_bf16 v[120:135], v[64:67], v[32:35], v[120:135]
    ds_read_b64_tr_b16 v[64:65], v0 offset:192
    ds_read_b64_tr_b16 v[66:67], v0 offset:2752
    s_waitcnt lgkmcnt(8)
    v_mfma_f32_32x32x16_bf16 v[136:151], v[68:71], v[32:35], v[136:151]
    ds_read_b64_tr_b16 v[68:69], v0 offset:256
    ds_read_b64_tr_b16 v[70:71], v0 offset:2816
    s_waitcnt lgkmcnt(8)
    v_mfma_f32_32x32x16_bf16 v[72:87], v[52:55], v[36:39], v[72:87]
    ds_read_b64_tr_b16 v[52:53], v10 offset:5120
    ds_read_b64_tr_b16 v[54:55], v10 offset:7680
    s_waitcnt lgkmcnt(8)
    v_mfma_f32_32x32x16_bf16 v[88:103], v[56:59], v[36:39], v[88:103]
    ds_read_b64_tr_b16 v[56:57], v10 offset:5184
    ds_read_b64_tr_b16 v[58:59], v10 offset:7744
    s_waitcnt lgkmcnt(8)
    v_mfma_f32_32x32x16_bf16 v[104:119], v[60:63], v[36:39], v[104:119]
    ds_read_b64_tr_b16 v[60:61], v10 offset:5248
    ds_read_b64_tr_b16 v[62:63], v10 offset:7808
    s_waitcnt lgkmcnt(8)
    v_mfma_f32_32x32x16_bf16 v[120:135], v[64:67], v[36:39], v[120:135]
    ds_read_b64_tr_b16 v[64:65], v10 offset:5312
    ds_read_b64_tr_b16 v[66:67], v10 offset:7872
    s_waitcnt lgkmcnt(8)
    v_mfma_f32_32x32x16_bf16 v[136:151], v[68:71], v[36:39], v[136:151]
    ds_read_b64_tr_b16 v[68:69], v10 offset:5376
    ds_read_b64_tr_b16 v[70:71], v10 offset:7936
    s_waitcnt lgkmcnt(8)
    v_mfma_f32_32x32x16_bf16 v[72:87], v[52:55], v[40:43], v[72:87]
    ds_read_b64_tr_b16 v[52:53], v10 offset:10240
    ds_read_b64_tr_b16 v[54:55], v10 offset:12800
    s_waitcnt lgkmcnt(8)
    v_mfma_f32_32x32x16_bf16 v[88:103], v[56:59], v[40:43], v[88:103]
    ds_read_b64_tr_b16 v[56:57], v10 offset:10304
    ds_read_b64_tr_b16 v[58:59], v10 offset:12864
    s_waitcnt lgkmcnt(8)
    v_mfma_f32_32x32x16_bf16 v[104:119], v[60:63], v[40:43], v[104:119]
    ds_read_b64_tr_b16 v[60:61], v10 offset:10368
    ds_read_b64_tr_b16 v[62:63], v10 offset:12928
    s_waitcnt lgkmcnt(8)
    v_mfma_f32_32x32x16_bf16 v[120:135], v[64:67], v[40:43], v[120:135]
    ds_read_b64_tr_b16 v[64:65], v10 offset:10432
    ds_read_b64_tr_b16 v[66:67], v10 offset:12992
    s_waitcnt lgkmcnt(8)
    v_mfma_f32_32x32x16_bf16 v[136:151], v[68:71], v[40:43], v[136:151]
    ds_read_b64_tr_b16 v[68:69], v10 offset:10496
    ds_read_b64_tr_b16 v[70:71], v10 offset:13056
    s_waitcnt lgkmcnt(8)
    v_mfma_f32_32x32x16_bf16 v[72:87], v[52:55], v[44:47], v[72:87]
    ds_read_b64_tr_b16 v[52:53], v10 offset:0
    ds_read_b64_tr_b16 v[54:55], v10 offset:2560
    s_waitcnt lgkmcnt(8)
    v_mfma_f32_32x32x16_bf16 v[88:103], v[56:59], v[44:47], v[88:103]
    ds_read_b64_tr_b16 v[56:57], v10 offset:64
    ds_read_b64_tr_b16 v[58:59], v10 offset:2624
    s_waitcnt lgkmcnt(8)
    v_mfma_f32_32x32x16_bf16 v[104:119], v[60:63], v[44:47], v[104:119]
    ds_read_b64_tr_b16 v[60:61], v10 offset:128
    ds_read_b64_tr_b16 v[62:63], v10 offset:2688
    s_waitcnt lgkmcnt(8)
    v_mfma_f32_32x32x16_bf16 v[120:135], v[64:67], v[44:47], v[120:135]
    ds_read_b64_tr_b16 v[64:65], v10 offset:192
    ds_read_b64_tr_b16 v[66:67], v10 offset:2752
    s_waitcnt lgkmcnt(8)
    v_mfma_f32_32x32x16_bf16 v[136:151], v[68:71], v[44:47], v[136:151]
    ds_read_b64_tr_b16 v[68:69], v10 offset:256
    ds_read_b64_tr_b16 v[70:71], v10 offset:2816
    s_waitcnt lgkmcnt(8)
    v_mfma_f32_32x32x16_bf16 v[72:87], v[52:55], v[48:51], v[72:87]
    s_waitcnt lgkmcnt(6)
    v_mfma_f32_32x32x16_bf16 v[88:103], v[56:59], v[48:51], v[88:103]
    s_waitcnt lgkmcnt(4)
    v_mfma_f32_32x32x16_bf16 v[104:119], v[60:63], v[48:51], v[104:119]
    s_waitcnt lgkmcnt(2)
    v_mfma_f32_32x32x16_bf16 v[120:135], v[64:67], v[48:51], v[120:135]
    s_waitcnt lgkmcnt(0)
    v_mfma_f32_32x32x16_bf16 v[136:151], v[68:71], v[48:51], v[136:151]
    s_nop 3
    ds_write_b128 v158, v[72:75] offset:0
    ds_write_b128 v159, v[76:79] offset:0
    ds_write_b128 v160, v[80:83] offset:0
    ds_write_b128 v161, v[84:87] offset:0
    ds_write_b128 v158, v[88:91] offset:128
    ds_write_b128 v159, v[92:95] offset:128
    ds_write_b128 v160, v[96:99] offset:128
    ds_write_b128 v161, v[100:103] offset:128
    ds_write_b128 v158, v[104:107] offset:256
    ds_write_b128 v159, v[108:111] offset:256
    ds_write_b128 v160, v[112:115] offset:256
    ds_write_b128 v161, v[116:119] offset:256
    ds_write_b128 v158, v[120:123] offset:384
    ds_write_b128 v159, v[124:127] offset:384
    ds_write_b128 v160, v[128:131] offset:384
    ds_write_b128 v161, v[132:135] offset:384
    ds_write_b128 v158, v[136:139] offset:512
    ds_write_b128 v159, v[140:143] offset:512
    ds_write_b128 v160, v[144:147] offset:512
    ds_write_b128 v161, v[148:151] offset:512
    s_waitcnt lgkmcnt(0)
    s_barrier
    v_add_u32 v162, s24, v152
    v_add_u32 v163, s25, v152
    v_add_u32 v164, s26, v152
    v_add_u32 v165, s27, v152
    ds_read_b128 v[72:75], v162
    ds_read_b128 v[76:79], v163
    ds_read_b128 v[80:83], v164
    ds_read_b128 v[84:87], v165
    v_add_u32 v162, s24, v153
    v_add_u32 v163, s25, v153
    v_add_u32 v164, s26, v153
    v_add_u32 v165, s27, v153
    ds_read_b128 v[88:91], v162
    ds_read_b128 v[92:95], v163
    ds_read_b128 v[96:99], v164
    ds_read_b128 v[100:103], v165
    v_add_u32 v162, s24, v154
    v_add_u32 v163, s25, v154
    v_add_u32 v164, s26, v154
    v_add_u32 v165, s27, v154
    ds_read_b128 v[104:107], v162
    ds_read_b128 v[108:111], v163
    ds_read_b128 v[112:115], v164
    ds_read_b128 v[116:119], v165
    s_waitcnt lgkmcnt(8)
    v_pk_add_f32 v[72:73], v[72:73], v[76:77]
    v_pk_add_f32 v[80:81], v[80:81], v[84:85]
    v_pk_add_f32 v[74:75], v[74:75], v[78:79]
    v_pk_add_f32 v[82:83], v[82:83], v[86:87]
    v_pk_add_f32 v[72:73], v[72:73], v[12:13]
    v_pk_add_f32 v[74:75], v[74:75], v[14:15]
    v_pk_add_f32 v[72:73], v[72:73], v[80:81]
    v_pk_add_f32 v[74:75], v[74:75], v[82:83]
    v_cvt_pk_bf16_f32 v72, v72, v73
    v_cvt_pk_bf16_f32 v73, v74, v75
    buffer_store_dwordx2 v[72:73], v4, s[20:23], s41 offen nt
    v_add_u32 v162, s24, v155
    v_add_u32 v163, s25, v155
    v_add_u32 v164, s26, v155
    v_add_u32 v165, s27, v155
    ds_read_b128 v[120:123], v162
    ds_read_b128 v[124:127], v163
    ds_read_b128 v[128:131], v164
    ds_read_b128 v[132:135], v165
    s_waitcnt lgkmcnt(8)
    v_pk_add_f32 v[88:89], v[88:89], v[92:93]
    v_pk_add_f32 v[96:97], v[96:97], v[100:101]
    v_pk_add_f32 v[90:91], v[90:91], v[94:95]
    v_pk_add_f32 v[98:99], v[98:99], v[102:103]
    v_pk_add_f32 v[88:89], v[88:89], v[16:17]
    v_pk_add_f32 v[90:91], v[90:91], v[18:19]
    v_pk_add_f32 v[88:89], v[88:89], v[96:97]
    v_pk_add_f32 v[90:91], v[90:91], v[98:99]
    v_cvt_pk_bf16_f32 v88, v88, v89
    v_cvt_pk_bf16_f32 v89, v90, v91
    buffer_store_dwordx2 v[88:89], v5, s[20:23], s41 offen nt
    v_add_u32 v162, s24, v156
    v_add_u32 v163, s25, v156
    v_add_u32 v164, s26, v156
    v_add_u32 v165, s27, v156
    ds_read_b128 v[136:139], v162
    ds_read_b128 v[140:143], v163
    ds_read_b128 v[144:147], v164
    ds_read_b128 v[148:151], v165
    s_waitcnt lgkmcnt(8)
    v_pk_add_f32 v[104:105], v[104:105], v[108:109]
    v_pk_add_f32 v[112:113], v[112:113], v[116:117]
    v_pk_add_f32 v[106:107], v[106:107], v[110:111]
    v_pk_add_f32 v[114:115], v[114:115], v[118:119]
    v_pk_add_f32 v[104:105], v[104:105], v[20:21]
    v_pk_add_f32 v[106:107], v[106:107], v[22:23]
    v_pk_add_f32 v[104:105], v[104:105], v[112:113]
    v_pk_add_f32 v[106:107], v[106:107], v[114:115]
    v_cvt_pk_bf16_f32 v104, v104, v105
    v_cvt_pk_bf16_f32 v105, v106, v107
    buffer_store_dwordx2 v[104:105], v6, s[20:23], s41 offen nt
    s_waitcnt lgkmcnt(4)
    v_pk_add_f32 v[120:121], v[120:121], v[124:125]
    v_pk_add_f32 v[128:129], v[128:129], v[132:133]
    v_pk_add_f32 v[122:123], v[122:123], v[126:127]
    v_pk_add_f32 v[130:131], v[130:131], v[134:135]
    v_pk_add_f32 v[120:121], v[120:121], v[24:25]
    v_pk_add_f32 v[122:123], v[122:123], v[26:27]
    v_pk_add_f32 v[120:121], v[120:121], v[128:129]
    v_pk_add_f32 v[122:123], v[122:123], v[130:131]
    v_cvt_pk_bf16_f32 v120, v120, v121
    v_cvt_pk_bf16_f32 v121, v122, v123
    buffer_store_dwordx2 v[120:121], v7, s[20:23], s41 offen nt
    s_waitcnt lgkmcnt(0)
    v_pk_add_f32 v[136:137], v[136:137], v[140:141]
    v_pk_add_f32 v[144:145], v[144:145], v[148:149]
    v_pk_add_f32 v[138:139], v[138:139], v[142:143]
    v_pk_add_f32 v[146:147], v[146:147], v[150:151]
    v_pk_add_f32 v[136:137], v[136:137], v[28:29]
    v_pk_add_f32 v[138:139], v[138:139], v[30:31]
    v_pk_add_f32 v[136:137], v[136:137], v[144:145]
    v_pk_add_f32 v[138:139], v[138:139], v[146:147]
    v_cvt_pk_bf16_f32 v136, v136, v137
    v_cvt_pk_bf16_f32 v137, v138, v139
    buffer_store_dwordx2 v[136:137], v8, s[20:23], s41 offen nt
    s_endpgm
F_end:
    s_endpgm
.section .rodata,"a"
.p2align 6
.amdhsa_kernel parallel_sum__grouped_kv_mqa__dense_activation_relu__prompt_kernel
  .amdhsa_next_free_vgpr 168
  .amdhsa_next_free_sgpr 72
  .amdhsa_accum_offset 168
  .amdhsa_group_segment_fixed_size 0
  .amdhsa_kernarg_size 88
  .amdhsa_user_sgpr_count 2
  .amdhsa_user_sgpr_kernarg_segment_ptr 1
  .amdhsa_system_sgpr_workgroup_id_x 1
.end_amdhsa_kernel
```
